```python
import torch

def _softmax(x, axis=-1):
    return torch.softmax(x, dim=axis)
def _gelu(x):
    return torch.nn.functional.gelu(x, approximate="tanh")
def _silu(x):
    return torch.nn.functional.silu(x)
def _sigmoid(x):
    return torch.sigmoid(x)
def _layernorm(x, axis=-1, eps=1e-5):
    m = x.mean(dim=axis, keepdim=True)
    v = x.var(dim=axis, keepdim=True, unbiased=False)
    return (x - m) / torch.sqrt(v + eps)
def _scatter_add(tgt, idx, src, axis=0):
    return tgt.clone().index_add_(axis, idx, src)
def _segment_sum(src, seg, n):
    out = torch.zeros((n,) + src.shape[1:], dtype=src.dtype)
    return out.index_add_(0, seg, src)
def _pad(x, pw):
    flat = tuple(v for pair in reversed(pw) for v in pair)
    return torch.nn.functional.pad(x, flat)

kernel_name = 'parallel_sum__sliding_local_dilated__dense_activation_gelu__prompt'

def setup_inputs():

    _w = (lambda a: (lambda t: t.to(torch.bfloat16) if t.is_floating_point() else t)(torch.as_tensor(a)))
    def _A_setup():
        B, S, D = 1, 2048, 448
        return {
            "x": _w((lambda *s: torch.randn(*s, dtype=torch.bfloat16) * 0.05)(B, S, D)),
            "wqkv": _w((lambda *s: torch.randn(*s, dtype=torch.bfloat16) * 0.05)(D, 3 * D)),
            "wo": _w((lambda *s: torch.randn(*s, dtype=torch.bfloat16) * 0.05)(D, D)),
        }
    _A_in = _A_setup()

    def _B_setup():
        B, S, D, F = 1, 2048, 448, 1792
        return {
            "x": _w((lambda *s: torch.randn(*s, dtype=torch.bfloat16) * 0.05)(B, S, D)),
            "w1": _w((lambda *s: torch.randn(*s, dtype=torch.bfloat16) * 0.8)(D, F) * (D ** -0.5)),
            "b1": _w((lambda *s: torch.randn(*s, dtype=torch.bfloat16) * 0.8)(F) * 0.01),
            "w2": _w((lambda *s: torch.randn(*s, dtype=torch.bfloat16) * 0.8)(F, D) * (F ** -0.5)),
            "b2": _w((lambda *s: torch.randn(*s, dtype=torch.bfloat16) * 0.8)(D) * 0.01),
        }
    _B_in = _B_setup()

    return {
        "A_x": _A_in["x"],
        "A_wqkv": _A_in["wqkv"],
        "A_wo": _A_in["wo"],
        "B_x": _B_in["x"],
        "B_w1": _B_in["w1"],
        "B_b1": _B_in["b1"],
        "B_w2": _B_in["w2"],
        "B_b2": _B_in["b2"],
    }

def reference(A_x, A_wqkv, A_wo, B_x, B_w1, B_b1, B_w2, B_b2):
    def _A_ref(x, wqkv, wo):
        B, S, D = x.shape
        H = 16; Dh = D // H
        W, dil = 8, 2
        qkv = (lambda x, *d: x.permute(*d))((x @ wqkv).reshape(B, S, 3, H, Dh), 2, 0, 3, 1, 4)
        q, k, v = qkv[0], qkv[1], qkv[2]
        scale = Dh ** -0.5
        pos = torch.arange(S)
        off = torch.arange(W) * dil
        idx = pos[:, None] - off[None, :]
        mask = idx >= 0
        idx_c = torch.where(mask, idx, 0).reshape(-1)
        kg = k[:, :, idx_c, :].reshape(B, H, S, W, Dh)
        vg = v[:, :, idx_c, :].reshape(B, H, S, W, Dh)
        logits = torch.einsum("bhsd,bhswd->bhsw", q, kg) * scale
        logits = torch.where(mask[None, None, :, :], logits, -1e9)
        attn = _softmax(logits, axis=-1)
        o = torch.einsum("bhsw,bhswd->bhsd", attn, vg)
        return (lambda x, *d: x.permute(*d))(o, 0, 2, 1, 3).reshape(B, S, D) @ wo

    def _B_ref(x, w1, b1, w2, b2):
        h = torch.einsum("bsd,df->bsf", x, w1) + b1
        h = _gelu(h)
        return torch.einsum("bsf,fd->bsd", h, w2) + b2

    x = A_x
    xn = _layernorm(x, axis=-1)
    return x + _A_ref(xn, A_wqkv, A_wo) + _B_ref(xn, B_w1, B_b1, B_w2, B_b2)
```

```asm
; @launch grid=(256,1,1) block=(768,1,1) lds=162048
.amdgcn_target "amdgcn-amd-amdhsa--gfx950"
.text
.globl parallel_sum__sliding_local_dilated__dense_activation_gelu__prompt_kernel
.p2align 8
.type parallel_sum__sliding_local_dilated__dense_activation_gelu__prompt_kernel,@function
parallel_sum__sliding_local_dilated__dense_activation_gelu__prompt_kernel:
  s_load_dwordx16 s[4:19], s[0:1], 0
  s_load_dwordx8 s[20:27], s[0:1], 56
  s_cmpk_ge_u32 s2, 256
  s_cbranch_scc1 L_end
  s_getpc_b64 s[28:29]
L_pc:
  s_lshr_b32 s3, s2, 3
  v_lshrrev_b32 v4, 6, v0
  v_mad_u32_u24 v5, s3, 12, v4
  v_readfirstlane_b32 s68, v4
  v_lshlrev_b32 v5, 7, v5
  v_min_u32 v5, L_codeend - L_pc - 4, v5
  global_load_dword v23, v5, s[28:29]
  s_bfe_u32 s75, s2, 131073
  s_lshl_b32 s75, s75, 3
  s_lshr_b32 s76, s3, 2
  s_add_u32 s70, s75, s76
  s_lshr_b32 s75, s70, 1
  s_lshl_b32 s75, s75, 7
  s_and_b32 s76, s70, 1
  s_add_u32 s74, s75, s76
  s_cmp_lt_u32 s68, 4
  s_cbranch_scc1 L_L
  v_lshrrev_b32 v6, 3, v0
  v_add_u32 v6, 32, v6
  v_and_b32 v6, 63, v6
  v_lshl_add_u32 v4, v6, 1, s74
  v_mul_u32_u24 v4, 896, v4
  v_and_b32 v5, 7, v0
  v_lshl_add_u32 v9, v5, 4, v4
  s_setprio 1
  s_waitcnt lgkmcnt(0)
  global_load_dwordx4 v[136:139], v9, s[4:5] offset:0
  global_load_dwordx4 v[140:143], v9, s[4:5] offset:128
  global_load_dwordx4 v[144:147], v9, s[4:5] offset:256
  global_load_dwordx4 v[148:151], v9, s[4:5] offset:384
  global_load_dwordx4 v[152:155], v9, s[4:5] offset:512
  global_load_dwordx4 v[156:159], v9, s[4:5] offset:640
  global_load_dwordx4 v[160:163], v9, s[4:5] offset:768
L_x256:
  v_and_b32 v1, 63, v0
  v_lshlrev_b32 v2, 4, v1
  s_and_b32 s71, s68, 3
  s_and_b32 s75, s2, 1
  s_lshl_b32 s75, s75, 2
  s_and_b32 s77, s3, 3
  s_add_u32 s69, s75, s77
  s_lshr_b32 s75, s3, 2
  s_and_b32 s64, s75, 3
  s_mul_i32 s64, s64, 2
  s_mul_i32 s65, s70, 1
  s_and_b32 s65, s65, 4
  s_xor_b32 s65, s65, s69
  s_sub_u32 s93, s68, 4
  s_and_b32 s72, s68, 1
  s_bfe_u32 s73, s68, 0x10001
  v_lshrrev_b32 v8, 4, v6
  v_and_b32 v5, 15, v6
  v_and_b32 v4, 3, v1
  v_bfe_u32 v6, v1, 2, 1
  v_mul_u32_u24 v3, 12, v6
  v_or_b32 v3, v3, v4
  v_xor_b32 v5, v5, v3
  v_lshlrev_b32 v5, 4, v5
  v_lshl_add_u32 v5, v4, 8, v5
  v_mul_u32_u24 v6, 4608, v6
  v_lshl_add_u32 v5, v8, 10, v5
  s_sub_u32 s75, 7, s64
  s_cmp_eq_u32 s64, 0
  s_cselect_b32 s75, 0, s75
  s_mul_i32 s75, s75, 9216
  s_movk_i32 s76, 9216
  v_add3_u32 v3, v5, v6, s75
  s_cmp_eq_u32 s64, 1
  s_cselect_b32 s75, -55296, s76
  v_add_u32 v40, s75, v3
  s_cmp_eq_u32 s64, 2
  s_cselect_b32 s75, -55296, s76
  v_add_u32 v41, s75, v40
  s_cmp_eq_u32 s64, 3
  s_cselect_b32 s75, -55296, s76
  v_add_u32 v42, s75, v41
  s_cmp_eq_u32 s64, 4
  s_cselect_b32 s75, -55296, s76
  v_add_u32 v43, s75, v42
  s_cmp_eq_u32 s64, 5
  s_cselect_b32 s75, -55296, s76
  v_add_u32 v44, s75, v43
  s_cmp_eq_u32 s64, 6
  s_cselect_b32 s75, -55296, s76
  v_add_u32 v45, s75, v44
  s_cmp_ge_u32 s68, 8
  s_cbranch_scc1 L_A2
  s_mov_b32 s40, s14
  s_and_b32 s41, s15, 0xffff
  s_mov_b32 s42, 3584
  s_mov_b32 s43, 0x20000
  s_mov_b32 s28, s4
  s_and_b32 s29, s5, 0xffff
  s_mov_b32 s30, 1835008
  s_mov_b32 s31, 0x20000
  v_lshrrev_b32 v4, 5, v1
  s_lshl_b32 s75, s71, 2
  s_add_u32 s75, s75, s74
  s_sub_u32 s75, s75, 16
  v_lshl_add_u32 v4, v4, 1, s75
  s_movk_i32 s78, 896
  v_mul_lo_u32 v4, v4, s78
  v_and_b32 v5, 31, v1
  v_cmp_gt_u32 vcc, 24, v5
  v_lshl_add_u32 v5, s64, 3, v5
  v_add_u32 v6, 32, v5
  v_subrev_u32 v7, 24, v5
  v_min_u32 v6, v6, v7
  v_lshl_add_u32 v6, v6, 4, v4
  v_subrev_u32 v7, 56, v5
  v_min_u32 v5, v5, v7
  v_lshl_add_u32 v4, v5, 4, v4
  v_mov_b32 v7, 2146435072
  v_cndmask_b32 v6, v7, v6, vcc
  v_min_u32 v20, v7, v4
  v_min_u32 v21, v7, v6
  s_mul_i32 s78, s69, 448
  s_mul_i32 s76, s73, 224
  s_add_u32 s78, s78, s76
  s_lshl_b32 s77, s71, 9
  s_add_u32 s77, s77, 151552
  v_lshlrev_b32 v22, 2, v1
  v_lshl_add_u32 v18, v1, 3, s77
  buffer_load_dword v76, v22, s[40:43], s78 offen
  buffer_load_dwordx4 v[28:31], v20, s[28:31], 0 offen
  buffer_load_dwordx4 v[36:39], v21, s[28:31], 0 offen
  v_lshrrev_b32 v6, 4, v1
  v_lshlrev_b32 v4, 3, v6
  v_lshl_add_u32 v19, v6, 4, s77
  v_bfe_u32 v5, v1, 2, 2
  v_add_u32 v4, v4, v5
  v_mul_u32_u24 v4, 448, v4
  v_and_b32 v5, 3, v1
  v_lshl_add_u32 v4, v5, 3, v4
  s_add_u32 s76, s76, 65536
  v_add_u32 v4, s76, v4
  v_and_b32 v5, 1, v6
  s_lshl_b32 s77, s73, 6
  s_sub_u32 s77, 32, s77
  v_mul_lo_u32 v5, v5, s77
  v_add_u32 v14, v4, v5
  v_sub_u32 v15, v4, v5
  v_add_u32 v16, 57344, v14
  v_add_u32 v17, 57344, v15
  s_mov_b32 s85, 0xc09d30fc
  s_mov_b32 s82, 0x3eeff558
  v_lshrrev_b32 v6, 4, v1
  v_and_b32 v7, 15, v1
  v_xor_b32 v4, v7, v6
  v_lshlrev_b32 v5, 8, v6
  s_lshl_b32 s75, s72, 11
  v_lshl_add_u32 v8, v4, 4, v5
  v_add_u32 v8, s75, v8
  v_xor_b32 v9, 192, v8
  s_mov_b32 s32, s26
  s_and_b32 s33, s27, 0xffff
  s_mov_b32 s34, 268435456
  s_mov_b32 s35, 0x20000
  s_mov_b32 s36, s22
  s_and_b32 s37, s23, 0xffff
  s_mov_b32 s38, 1835008
  s_mov_b32 s39, 0x20000
  s_sub_u32 s77, 0, s32
  s_and_b32 s77, s77, 0xfffff
  s_lshl_b32 s3, s70, 20
  s_add_u32 s3, s3, s77
  s_mul_i32 s77, s70, 1
  s_and_b32 s77, s77, 7
  s_xor_b32 s81, s77, s93
  s_lshl_b32 s81, s81, 10
  s_add_u32 s84, s3, s81
  s_mul_i32 s97, s65, 147456
  s_add_u32 s97, s97, s84
  s_add_u32 s84, s84, 917504
  s_add_u32 s3, s3, 917504
  v_lshrrev_b32 v4, 2, v1
  v_bfe_u32 v5, v1, 3, 2
  s_lshr_b32 s77, s93, 1
  v_xor_b32 v5, s77, v5
  v_lshlrev_b32 v5, 5, v5
  v_lshl_add_u32 v5, v4, 7, v5
  v_and_b32 v4, 3, v1
  v_lshl_add_u32 v12, v4, 3, v5
  v_add_u32 v10, 65536, v12
  v_add_u32 v11, 122880, v12
  v_xor_b32 v13, 64, v12
  s_waitcnt vmcnt(9)
  v_lshlrev_b32 v80, 16, v136
  v_and_b32 v81, 0xffff0000, v136
  v_pk_mul_f32 v[6:7], v[80:81], v[80:81]
  v_lshlrev_b32 v82, 16, v137
  v_and_b32 v83, 0xffff0000, v137
  v_pk_add_f32 v[4:5], v[80:81], v[82:83]
  v_pk_fma_f32 v[6:7], v[82:83], v[82:83], v[6:7]
  v_lshlrev_b32 v84, 16, v138
  v_and_b32 v85, 0xffff0000, v138
  v_pk_add_f32 v[4:5], v[4:5], v[84:85]
  v_pk_fma_f32 v[6:7], v[84:85], v[84:85], v[6:7]
  v_lshlrev_b32 v86, 16, v139
  v_and_b32 v87, 0xffff0000, v139
  v_pk_add_f32 v[4:5], v[4:5], v[86:87]
  v_pk_fma_f32 v[6:7], v[86:87], v[86:87], v[6:7]
  s_waitcnt vmcnt(8)
  v_lshlrev_b32 v88, 16, v140
  v_and_b32 v89, 0xffff0000, v140
  v_pk_add_f32 v[4:5], v[4:5], v[88:89]
  v_pk_fma_f32 v[6:7], v[88:89], v[88:89], v[6:7]
  v_lshlrev_b32 v90, 16, v141
  v_and_b32 v91, 0xffff0000, v141
  v_pk_add_f32 v[4:5], v[4:5], v[90:91]
  v_pk_fma_f32 v[6:7], v[90:91], v[90:91], v[6:7]
  v_lshlrev_b32 v92, 16, v142
  v_and_b32 v93, 0xffff0000, v142
  v_pk_add_f32 v[4:5], v[4:5], v[92:93]
  v_pk_fma_f32 v[6:7], v[92:93], v[92:93], v[6:7]
  v_lshlrev_b32 v94, 16, v143
  v_and_b32 v95, 0xffff0000, v143
  v_pk_add_f32 v[4:5], v[4:5], v[94:95]
  v_pk_fma_f32 v[6:7], v[94:95], v[94:95], v[6:7]
  s_waitcnt vmcnt(7)
  v_lshlrev_b32 v96, 16, v144
  v_and_b32 v97, 0xffff0000, v144
  v_pk_add_f32 v[4:5], v[4:5], v[96:97]
  v_pk_fma_f32 v[6:7], v[96:97], v[96:97], v[6:7]
  v_lshlrev_b32 v98, 16, v145
  v_and_b32 v99, 0xffff0000, v145
  v_pk_add_f32 v[4:5], v[4:5], v[98:99]
  v_pk_fma_f32 v[6:7], v[98:99], v[98:99], v[6:7]
  v_lshlrev_b32 v100, 16, v146
  v_and_b32 v101, 0xffff0000, v146
  v_pk_add_f32 v[4:5], v[4:5], v[100:101]
  v_pk_fma_f32 v[6:7], v[100:101], v[100:101], v[6:7]
  v_lshlrev_b32 v102, 16, v147
  v_and_b32 v103, 0xffff0000, v147
  v_pk_add_f32 v[4:5], v[4:5], v[102:103]
  v_pk_fma_f32 v[6:7], v[102:103], v[102:103], v[6:7]
  s_waitcnt vmcnt(6)
  v_lshlrev_b32 v104, 16, v148
  v_and_b32 v105, 0xffff0000, v148
  v_pk_add_f32 v[4:5], v[4:5], v[104:105]
  v_pk_fma_f32 v[6:7], v[104:105], v[104:105], v[6:7]
  v_lshlrev_b32 v106, 16, v149
  v_and_b32 v107, 0xffff0000, v149
  v_pk_add_f32 v[4:5], v[4:5], v[106:107]
  v_pk_fma_f32 v[6:7], v[106:107], v[106:107], v[6:7]
  v_lshlrev_b32 v108, 16, v150
  v_and_b32 v109, 0xffff0000, v150
  v_pk_add_f32 v[4:5], v[4:5], v[108:109]
  v_pk_fma_f32 v[6:7], v[108:109], v[108:109], v[6:7]
  v_lshlrev_b32 v110, 16, v151
  v_and_b32 v111, 0xffff0000, v151
  v_pk_add_f32 v[4:5], v[4:5], v[110:111]
  v_pk_fma_f32 v[6:7], v[110:111], v[110:111], v[6:7]
  s_waitcnt vmcnt(5)
  v_lshlrev_b32 v112, 16, v152
  v_and_b32 v113, 0xffff0000, v152
  v_pk_add_f32 v[4:5], v[4:5], v[112:113]
  v_pk_fma_f32 v[6:7], v[112:113], v[112:113], v[6:7]
  v_lshlrev_b32 v114, 16, v153
  v_and_b32 v115, 0xffff0000, v153
  v_pk_add_f32 v[4:5], v[4:5], v[114:115]
  v_pk_fma_f32 v[6:7], v[114:115], v[114:115], v[6:7]
  v_lshlrev_b32 v116, 16, v154
  v_and_b32 v117, 0xffff0000, v154
  v_pk_add_f32 v[4:5], v[4:5], v[116:117]
  v_pk_fma_f32 v[6:7], v[116:117], v[116:117], v[6:7]
  v_lshlrev_b32 v118, 16, v155
  v_and_b32 v119, 0xffff0000, v155
  v_pk_add_f32 v[4:5], v[4:5], v[118:119]
  v_pk_fma_f32 v[6:7], v[118:119], v[118:119], v[6:7]
  s_waitcnt vmcnt(4)
  v_lshlrev_b32 v120, 16, v156
  v_and_b32 v121, 0xffff0000, v156
  v_pk_add_f32 v[4:5], v[4:5], v[120:121]
  v_pk_fma_f32 v[6:7], v[120:121], v[120:121], v[6:7]
  v_lshlrev_b32 v122, 16, v157
  v_and_b32 v123, 0xffff0000, v157
  v_pk_add_f32 v[4:5], v[4:5], v[122:123]
  v_pk_fma_f32 v[6:7], v[122:123], v[122:123], v[6:7]
  v_lshlrev_b32 v124, 16, v158
  v_and_b32 v125, 0xffff0000, v158
  v_pk_add_f32 v[4:5], v[4:5], v[124:125]
  v_pk_fma_f32 v[6:7], v[124:125], v[124:125], v[6:7]
  v_lshlrev_b32 v126, 16, v159
  v_and_b32 v127, 0xffff0000, v159
  v_pk_add_f32 v[4:5], v[4:5], v[126:127]
  v_pk_fma_f32 v[6:7], v[126:127], v[126:127], v[6:7]
  s_waitcnt vmcnt(3)
  v_lshlrev_b32 v128, 16, v160
  v_and_b32 v129, 0xffff0000, v160
  v_pk_add_f32 v[4:5], v[4:5], v[128:129]
  v_pk_fma_f32 v[6:7], v[128:129], v[128:129], v[6:7]
  v_lshlrev_b32 v130, 16, v161
  v_and_b32 v131, 0xffff0000, v161
  v_pk_add_f32 v[4:5], v[4:5], v[130:131]
  v_pk_fma_f32 v[6:7], v[130:131], v[130:131], v[6:7]
  v_lshlrev_b32 v132, 16, v162
  v_and_b32 v133, 0xffff0000, v162
  v_pk_add_f32 v[4:5], v[4:5], v[132:133]
  v_pk_fma_f32 v[6:7], v[132:133], v[132:133], v[6:7]
  v_lshlrev_b32 v134, 16, v163
  v_and_b32 v135, 0xffff0000, v163
  v_pk_add_f32 v[4:5], v[4:5], v[134:135]
  v_pk_fma_f32 v[6:7], v[134:135], v[134:135], v[6:7]
  v_add_f32 v4, v4, v5
  v_add_f32 v6, v6, v7
  s_nop 0
  v_add_f32_dpp v4, v4, v4 quad_perm:[1,0,3,2] row_mask:0xf bank_mask:0xf
  v_add_f32_dpp v6, v6, v6 quad_perm:[1,0,3,2] row_mask:0xf bank_mask:0xf
  s_nop 0
  v_add_f32_dpp v4, v4, v4 quad_perm:[2,3,0,1] row_mask:0xf bank_mask:0xf
  v_add_f32_dpp v6, v6, v6 quad_perm:[2,3,0,1] row_mask:0xf bank_mask:0xf
  s_nop 0
  v_add_f32_dpp v4, v4, v4 row_half_mirror row_mask:0xf bank_mask:0xf
  v_add_f32_dpp v6, v6, v6 row_half_mirror row_mask:0xf bank_mask:0xf
  s_nop 0
  v_mul_f32 v4, 0x3b124925, v4
  v_mul_f32 v6, 0x3b124925, v6
  v_fma_f32 v6, -v4, v4, v6
  v_max_f32 v6, 0, v6
  v_cvt_pk_bf16_f32 v7, v4, v6
  v_and_b32 v6, 0xffff0000, v7
  v_add_f32 v6, 0x3727c5ac, v6
  v_cvt_pk_bf16_f32 v6, v6, v6
  v_lshlrev_b32 v6, 16, v6
  v_sqrt_f32 v6, v6
  v_lshlrev_b32 v4, 16, v7
  v_cvt_pk_bf16_f32 v6, v6, v6
  v_lshlrev_b32 v6, 16, v6
  v_rcp_f32 v6, v6
  s_nop 0
  v_mul_f32 v6, 0x3eeff558, v6
  v_mul_f32 v4, v4, v6
  .p2align 3
  v_pk_fma_f32 v[80:81], v[80:81], v[6:7], v[4:5] op_sel_hi:[1,0,0] neg_lo:[0,0,1] neg_hi:[0,0,1]
  v_pk_fma_f32 v[82:83], v[82:83], v[6:7], v[4:5] op_sel_hi:[1,0,0] neg_lo:[0,0,1] neg_hi:[0,0,1]
  v_cvt_pk_bf16_f32 v136, v80, v81
  v_pk_fma_f32 v[84:85], v[84:85], v[6:7], v[4:5] op_sel_hi:[1,0,0] neg_lo:[0,0,1] neg_hi:[0,0,1]
  v_cvt_pk_bf16_f32 v137, v82, v83
  v_pk_fma_f32 v[86:87], v[86:87], v[6:7], v[4:5] op_sel_hi:[1,0,0] neg_lo:[0,0,1] neg_hi:[0,0,1]
  v_cvt_pk_bf16_f32 v138, v84, v85
  v_pk_fma_f32 v[88:89], v[88:89], v[6:7], v[4:5] op_sel_hi:[1,0,0] neg_lo:[0,0,1] neg_hi:[0,0,1]
  v_cvt_pk_bf16_f32 v139, v86, v87
  ds_write_b128 v3, v[136:139]
  v_pk_fma_f32 v[90:91], v[90:91], v[6:7], v[4:5] op_sel_hi:[1,0,0] neg_lo:[0,0,1] neg_hi:[0,0,1]
  v_cvt_pk_bf16_f32 v140, v88, v89
  v_pk_fma_f32 v[92:93], v[92:93], v[6:7], v[4:5] op_sel_hi:[1,0,0] neg_lo:[0,0,1] neg_hi:[0,0,1]
  v_cvt_pk_bf16_f32 v141, v90, v91
  v_pk_fma_f32 v[94:95], v[94:95], v[6:7], v[4:5] op_sel_hi:[1,0,0] neg_lo:[0,0,1] neg_hi:[0,0,1]
  v_cvt_pk_bf16_f32 v142, v92, v93
  v_pk_fma_f32 v[96:97], v[96:97], v[6:7], v[4:5] op_sel_hi:[1,0,0] neg_lo:[0,0,1] neg_hi:[0,0,1]
  v_cvt_pk_bf16_f32 v143, v94, v95
  ds_write_b128 v40, v[140:143]
  v_pk_fma_f32 v[98:99], v[98:99], v[6:7], v[4:5] op_sel_hi:[1,0,0] neg_lo:[0,0,1] neg_hi:[0,0,1]
  v_cvt_pk_bf16_f32 v144, v96, v97
  v_pk_fma_f32 v[100:101], v[100:101], v[6:7], v[4:5] op_sel_hi:[1,0,0] neg_lo:[0,0,1] neg_hi:[0,0,1]
  v_cvt_pk_bf16_f32 v145, v98, v99
  v_pk_fma_f32 v[102:103], v[102:103], v[6:7], v[4:5] op_sel_hi:[1,0,0] neg_lo:[0,0,1] neg_hi:[0,0,1]
  v_cvt_pk_bf16_f32 v146, v100, v101
  v_pk_fma_f32 v[104:105], v[104:105], v[6:7], v[4:5] op_sel_hi:[1,0,0] neg_lo:[0,0,1] neg_hi:[0,0,1]
  v_cvt_pk_bf16_f32 v147, v102, v103
  ds_write_b128 v41, v[144:147]
  v_pk_fma_f32 v[106:107], v[106:107], v[6:7], v[4:5] op_sel_hi:[1,0,0] neg_lo:[0,0,1] neg_hi:[0,0,1]
  v_cvt_pk_bf16_f32 v148, v104, v105
  v_pk_fma_f32 v[108:109], v[108:109], v[6:7], v[4:5] op_sel_hi:[1,0,0] neg_lo:[0,0,1] neg_hi:[0,0,1]
  v_cvt_pk_bf16_f32 v149, v106, v107
  v_pk_fma_f32 v[110:111], v[110:111], v[6:7], v[4:5] op_sel_hi:[1,0,0] neg_lo:[0,0,1] neg_hi:[0,0,1]
  v_cvt_pk_bf16_f32 v150, v108, v109
  v_pk_fma_f32 v[112:113], v[112:113], v[6:7], v[4:5] op_sel_hi:[1,0,0] neg_lo:[0,0,1] neg_hi:[0,0,1]
  v_cvt_pk_bf16_f32 v151, v110, v111
  ds_write_b128 v42, v[148:151]
  v_pk_fma_f32 v[114:115], v[114:115], v[6:7], v[4:5] op_sel_hi:[1,0,0] neg_lo:[0,0,1] neg_hi:[0,0,1]
  v_cvt_pk_bf16_f32 v152, v112, v113
  v_pk_fma_f32 v[116:117], v[116:117], v[6:7], v[4:5] op_sel_hi:[1,0,0] neg_lo:[0,0,1] neg_hi:[0,0,1]
  v_cvt_pk_bf16_f32 v153, v114, v115
  v_pk_fma_f32 v[118:119], v[118:119], v[6:7], v[4:5] op_sel_hi:[1,0,0] neg_lo:[0,0,1] neg_hi:[0,0,1]
  v_cvt_pk_bf16_f32 v154, v116, v117
  v_pk_fma_f32 v[120:121], v[120:121], v[6:7], v[4:5] op_sel_hi:[1,0,0] neg_lo:[0,0,1] neg_hi:[0,0,1]
  v_cvt_pk_bf16_f32 v155, v118, v119
  ds_write_b128 v43, v[152:155]
  v_pk_fma_f32 v[122:123], v[122:123], v[6:7], v[4:5] op_sel_hi:[1,0,0] neg_lo:[0,0,1] neg_hi:[0,0,1]
  v_cvt_pk_bf16_f32 v156, v120, v121
  v_pk_fma_f32 v[124:125], v[124:125], v[6:7], v[4:5] op_sel_hi:[1,0,0] neg_lo:[0,0,1] neg_hi:[0,0,1]
  v_cvt_pk_bf16_f32 v157, v122, v123
  v_pk_fma_f32 v[126:127], v[126:127], v[6:7], v[4:5] op_sel_hi:[1,0,0] neg_lo:[0,0,1] neg_hi:[0,0,1]
  v_cvt_pk_bf16_f32 v158, v124, v125
  v_pk_fma_f32 v[128:129], v[128:129], v[6:7], v[4:5] op_sel_hi:[1,0,0] neg_lo:[0,0,1] neg_hi:[0,0,1]
  v_cvt_pk_bf16_f32 v159, v126, v127
  ds_write_b128 v44, v[156:159]
  v_pk_fma_f32 v[130:131], v[130:131], v[6:7], v[4:5] op_sel_hi:[1,0,0] neg_lo:[0,0,1] neg_hi:[0,0,1]
  v_cvt_pk_bf16_f32 v160, v128, v129
  v_pk_fma_f32 v[132:133], v[132:133], v[6:7], v[4:5] op_sel_hi:[1,0,0] neg_lo:[0,0,1] neg_hi:[0,0,1]
  v_cvt_pk_bf16_f32 v161, v130, v131
  v_pk_fma_f32 v[134:135], v[134:135], v[6:7], v[4:5] op_sel_hi:[1,0,0] neg_lo:[0,0,1] neg_hi:[0,0,1]
  v_cvt_pk_bf16_f32 v162, v132, v133
  v_cvt_pk_bf16_f32 v163, v134, v135
  ds_write_b128 v45, v[160:163]
  s_setprio 0
  s_waitcnt vmcnt(2)
  v_and_b32 v77, 0xffff0000, v76
  v_lshlrev_b32 v76, 16, v76
  v_mul_f32 v77, s82, v77
  v_mul_f32 v76, s82, v76
  ds_write_b64 v18, v[76:77]
  ds_read_b128 v[24:27], v19 offset:0
  ds_read_b128 v[32:35], v19 offset:64
  ds_read_b128 v[40:43], v19 offset:128
  ds_read_b128 v[48:51], v19 offset:192
  ds_read_b128 v[56:59], v19 offset:256
  ds_read_b128 v[64:67], v19 offset:320
  ds_read_b128 v[72:75], v19 offset:384
  s_waitcnt vmcnt(1)
  v_lshlrev_b32 v80, 16, v28
  v_and_b32 v81, 0xffff0000, v28
  v_pk_mul_f32 v[6:7], v[80:81], v[80:81]
  v_lshlrev_b32 v82, 16, v29
  v_and_b32 v83, 0xffff0000, v29
  v_pk_add_f32 v[4:5], v[80:81], v[82:83]
  v_pk_fma_f32 v[6:7], v[82:83], v[82:83], v[6:7]
  v_lshlrev_b32 v84, 16, v30
  v_and_b32 v85, 0xffff0000, v30
  v_pk_add_f32 v[4:5], v[4:5], v[84:85]
  v_pk_fma_f32 v[6:7], v[84:85], v[84:85], v[6:7]
  v_lshlrev_b32 v86, 16, v31
  v_and_b32 v87, 0xffff0000, v31
  v_pk_add_f32 v[4:5], v[4:5], v[86:87]
  v_pk_fma_f32 v[6:7], v[86:87], v[86:87], v[6:7]
  s_waitcnt vmcnt(0)
  v_lshlrev_b32 v88, 16, v36
  v_and_b32 v89, 0xffff0000, v36
  v_pk_add_f32 v[4:5], v[4:5], v[88:89]
  v_pk_fma_f32 v[6:7], v[88:89], v[88:89], v[6:7]
  v_lshlrev_b32 v90, 16, v37
  v_and_b32 v91, 0xffff0000, v37
  v_pk_add_f32 v[4:5], v[4:5], v[90:91]
  v_pk_fma_f32 v[6:7], v[90:91], v[90:91], v[6:7]
  v_lshlrev_b32 v92, 16, v38
  v_and_b32 v93, 0xffff0000, v38
  v_pk_add_f32 v[4:5], v[4:5], v[92:93]
  v_pk_fma_f32 v[6:7], v[92:93], v[92:93], v[6:7]
  v_lshlrev_b32 v94, 16, v39
  v_and_b32 v95, 0xffff0000, v39
  v_pk_add_f32 v[4:5], v[4:5], v[94:95]
  v_pk_fma_f32 v[6:7], v[94:95], v[94:95], v[6:7]
  v_add_f32 v4, v4, v5
  v_add_f32 v6, v6, v7
  s_nop 0
  v_add_f32_dpp v4, v4, v4 quad_perm:[1,0,3,2] row_mask:0xf bank_mask:0xf
  v_add_f32_dpp v6, v6, v6 quad_perm:[1,0,3,2] row_mask:0xf bank_mask:0xf
  s_nop 0
  v_add_f32_dpp v4, v4, v4 quad_perm:[2,3,0,1] row_mask:0xf bank_mask:0xf
  v_add_f32_dpp v6, v6, v6 quad_perm:[2,3,0,1] row_mask:0xf bank_mask:0xf
  s_nop 0
  v_add_f32_dpp v4, v4, v4 row_half_mirror row_mask:0xf bank_mask:0xf
  v_add_f32_dpp v6, v6, v6 row_half_mirror row_mask:0xf bank_mask:0xf
  s_nop 0
  v_add_f32_dpp v4, v4, v4 row_mirror row_mask:0xf bank_mask:0xf
  v_add_f32_dpp v6, v6, v6 row_mirror row_mask:0xf bank_mask:0xf
  s_nop 0
  v_mov_b32 v5, v4
  v_mov_b32 v7, v6
  s_nop 1
  v_permlane16_swap_b32 v4, v5
  v_permlane16_swap_b32 v6, v7
  s_nop 1
  v_add_f32 v4, v4, v5
  v_add_f32 v6, v6, v7
  v_mul_f32 v4, 0x3b124925, v4
  v_mul_f32 v6, 0x3b124925, v6
  v_fma_f32 v6, -v4, v4, v6
  v_max_f32 v6, 0, v6
  v_cvt_pk_bf16_f32 v7, v4, v6
  v_and_b32 v6, 0xffff0000, v7
  v_add_f32 v6, 0x3727c5ac, v6
  v_cvt_pk_bf16_f32 v6, v6, v6
  v_lshlrev_b32 v6, 16, v6
  v_sqrt_f32 v6, v6
  v_lshlrev_b32 v4, 16, v7
  v_cvt_pk_bf16_f32 v6, v6, v6
  v_lshlrev_b32 v6, 16, v6
  v_rcp_f32 v6, v6
  s_nop 0
  v_mul_f32 v6, 0x3eeff558, v6
  v_mul_f32 v4, v4, v6
  .p2align 3
  v_pk_fma_f32 v[80:81], v[80:81], v[6:7], v[4:5] op_sel_hi:[1,0,0] neg_lo:[0,0,1] neg_hi:[0,0,1]
  v_pk_fma_f32 v[82:83], v[82:83], v[6:7], v[4:5] op_sel_hi:[1,0,0] neg_lo:[0,0,1] neg_hi:[0,0,1]
  v_cvt_pk_bf16_f32 v28, v80, v81
  v_pk_fma_f32 v[84:85], v[84:85], v[6:7], v[4:5] op_sel_hi:[1,0,0] neg_lo:[0,0,1] neg_hi:[0,0,1]
  v_cvt_pk_bf16_f32 v29, v82, v83
  v_pk_fma_f32 v[86:87], v[86:87], v[6:7], v[4:5] op_sel_hi:[1,0,0] neg_lo:[0,0,1] neg_hi:[0,0,1]
  v_cvt_pk_bf16_f32 v30, v84, v85
  v_pk_fma_f32 v[88:89], v[88:89], v[6:7], v[4:5] op_sel_hi:[1,0,0] neg_lo:[0,0,1] neg_hi:[0,0,1]
  v_cvt_pk_bf16_f32 v31, v86, v87
  v_pk_fma_f32 v[90:91], v[90:91], v[6:7], v[4:5] op_sel_hi:[1,0,0] neg_lo:[0,0,1] neg_hi:[0,0,1]
  v_cvt_pk_bf16_f32 v36, v88, v89
  v_pk_fma_f32 v[92:93], v[92:93], v[6:7], v[4:5] op_sel_hi:[1,0,0] neg_lo:[0,0,1] neg_hi:[0,0,1]
  v_cvt_pk_bf16_f32 v37, v90, v91
  v_pk_fma_f32 v[94:95], v[94:95], v[6:7], v[4:5] op_sel_hi:[1,0,0] neg_lo:[0,0,1] neg_hi:[0,0,1]
  v_cvt_pk_bf16_f32 v38, v92, v93
  v_cvt_pk_bf16_f32 v39, v94, v95
  v_lshrrev_b32 v4, 5, v1
  s_lshl_b32 s75, s71, 1
  v_add_u32 v4, s75, v4
  v_and_b32 v5, 7, v1
  v_xor_b32 v4, v4, v5
  v_lshlrev_b32 v4, 4, v4
  v_and_b32 v5, 3, v1
  v_lshl_add_u32 v4, v5, 7, v4
  v_bfe_u32 v5, v1, 2, 3
  v_mul_u32_u24 v5, 4608, v5
  v_add_u32 v6, v4, v5
  ds_write_b128 v6, v[28:31] offset:4096
  s_mov_b32 exec_lo, 0x00ffffff
  s_mov_b32 exec_hi, 0x00ffffff
  ds_write_b128 v6, v[36:39] offset:40960
  s_mov_b64 exec, 0xff
  v_lshlrev_b32 v4, 2, v1
  v_add_u32 v4, 161920, v4
  v_mov_b32 v5, 0
  ds_write_b32 v4, v5
  s_mov_b64 exec, -1
  s_lshl_b32 s75, s72, 11
  s_add_u32 s75, s75, 57344
  v_add_u32 v3, s75, v2
  s_setprio 2
  s_waitcnt lgkmcnt(0)
  s_barrier
  ds_read_b128 v[88:91], v8 offset:1024
  ds_read_b64_tr_b16 v[112:113], v14 offset:0
  ds_read_b64_tr_b16 v[114:115], v14 offset:1792
  ds_read_b128 v[92:95], v9 offset:5632
  ds_read_b64_tr_b16 v[116:117], v14 offset:14336
  ds_read_b64_tr_b16 v[118:119], v14 offset:16128
  ds_read_b128 v[84:87], v9 offset:4608
  ds_read_b128 v[80:83], v8 offset:0
  ds_read_b64_tr_b16 v[120:121], v15 offset:32
  ds_read_b64_tr_b16 v[122:123], v15 offset:1824
  s_waitcnt lgkmcnt(7)
  v_mfma_f32_16x16x32_bf16 v[28:31], v[112:115], v[88:91], v[24:27]
  ds_read_b64_tr_b16 v[124:125], v15 offset:14368
  ds_read_b64_tr_b16 v[126:127], v15 offset:16160
  s_waitcnt lgkmcnt(6)
  v_mfma_f32_16x16x32_bf16 v[28:31], v[116:119], v[92:95], v[28:31]
  ds_read_b64_tr_b16 v[128:129], v14 offset:64
  ds_read_b64_tr_b16 v[130:131], v14 offset:1856
  s_waitcnt lgkmcnt(7)
  v_mfma_f32_16x16x32_bf16 v[24:27], v[116:119], v[84:87], v[24:27]
  ds_read_b64_tr_b16 v[132:133], v14 offset:14400
  ds_read_b64_tr_b16 v[134:135], v14 offset:16192
  s_waitcnt lgkmcnt(8)
  v_mfma_f32_16x16x32_bf16 v[24:27], v[112:115], v[80:83], v[24:27]
  ds_read_b64_tr_b16 v[136:137], v15 offset:96
  ds_read_b64_tr_b16 v[138:139], v15 offset:1888
  s_waitcnt lgkmcnt(8)
  v_mfma_f32_16x16x32_bf16 v[36:39], v[120:123], v[88:91], v[32:35]
  ds_read_b64_tr_b16 v[140:141], v15 offset:14432
  ds_read_b64_tr_b16 v[142:143], v15 offset:16224
  s_waitcnt lgkmcnt(8)
  v_mfma_f32_16x16x32_bf16 v[36:39], v[124:127], v[92:95], v[36:39]
  ds_read_b64_tr_b16 v[144:145], v14 offset:128
  ds_read_b64_tr_b16 v[146:147], v14 offset:1920
  v_mfma_f32_16x16x32_bf16 v[32:35], v[124:127], v[84:87], v[32:35]
  ds_read_b64_tr_b16 v[148:149], v14 offset:14464
  ds_read_b64_tr_b16 v[150:151], v14 offset:16256
  v_mfma_f32_16x16x32_bf16 v[32:35], v[120:123], v[80:83], v[32:35]
  ds_read_b64_tr_b16 v[112:113], v15 offset:160
  ds_read_b64_tr_b16 v[114:115], v15 offset:1952
  s_waitcnt lgkmcnt(12)
  v_mfma_f32_16x16x32_bf16 v[44:47], v[128:131], v[88:91], v[40:43]
  ds_read_b64_tr_b16 v[116:117], v15 offset:14496
  ds_read_b64_tr_b16 v[118:119], v15 offset:16288
  s_waitcnt lgkmcnt(12)
  v_mfma_f32_16x16x32_bf16 v[44:47], v[132:135], v[92:95], v[44:47]
  ds_read_b64_tr_b16 v[120:121], v14 offset:192
  v_mfma_f32_16x16x32_bf16 v[40:43], v[132:135], v[84:87], v[40:43]
  ds_read_b64_tr_b16 v[122:123], v14 offset:1984
  v_mfma_f32_16x16x32_bf16 v[40:43], v[128:131], v[80:83], v[40:43]
  ds_read_b64_tr_b16 v[124:125], v14 offset:14528
  s_waitcnt lgkmcnt(13)
  v_mfma_f32_16x16x32_bf16 v[52:55], v[136:139], v[88:91], v[48:51]
  ds_read_b64_tr_b16 v[126:127], v14 offset:16320
  s_waitcnt lgkmcnt(12)
  v_mfma_f32_16x16x32_bf16 v[52:55], v[140:143], v[92:95], v[52:55]
  ds_read_b128 v[96:99], v8 offset:9216
  v_mfma_f32_16x16x32_bf16 v[48:51], v[140:143], v[84:87], v[48:51]
  ds_read_b128 v[100:103], v9 offset:13824
  v_mfma_f32_16x16x32_bf16 v[48:51], v[136:139], v[80:83], v[48:51]
  ds_read_b128 v[108:111], v9 offset:14848
  s_waitcnt lgkmcnt(3)
  s_barrier
  v_mfma_f32_16x16x32_bf16 v[60:63], v[144:147], v[88:91], v[56:59]
  ds_read_b64_tr_b16 v[128:129], v14 offset:28672
  ds_read_b64_tr_b16 v[130:131], v14 offset:30464
  v_mfma_f32_16x16x32_bf16 v[60:63], v[148:151], v[92:95], v[60:63]
  ds_read_b64_tr_b16 v[132:133], v14 offset:43008
  ds_read_b64_tr_b16 v[134:135], v14 offset:44800
  v_mfma_f32_16x16x32_bf16 v[56:59], v[148:151], v[84:87], v[56:59]
  ds_read_b64_tr_b16 v[136:137], v15 offset:28704
  ds_read_b64_tr_b16 v[138:139], v15 offset:30496
  v_mfma_f32_16x16x32_bf16 v[56:59], v[144:147], v[80:83], v[56:59]
  ds_read_b64_tr_b16 v[140:141], v15 offset:43040
  ds_read_b128 v[104:107], v8 offset:10240
  v_mfma_f32_16x16x32_bf16 v[68:71], v[112:115], v[88:91], v[64:67]
  ds_read_b64_tr_b16 v[142:143], v15 offset:44832
  v_mfma_f32_16x16x32_bf16 v[68:71], v[116:119], v[92:95], v[68:71]
  ds_read_b64_tr_b16 v[144:145], v14 offset:28736
  v_mfma_f32_16x16x32_bf16 v[64:67], v[116:119], v[84:87], v[64:67]
  ds_read_b64_tr_b16 v[146:147], v14 offset:30528
  v_mfma_f32_16x16x32_bf16 v[64:67], v[112:115], v[80:83], v[64:67]
  ds_read_b64_tr_b16 v[148:149], v14 offset:43072
  v_mfma_f32_16x16x32_bf16 v[76:79], v[120:123], v[88:91], v[72:75]
  ds_read_b64_tr_b16 v[150:151], v14 offset:44864
  v_mfma_f32_16x16x32_bf16 v[76:79], v[124:127], v[92:95], v[76:79]
  ds_read_b64_tr_b16 v[112:113], v15 offset:28768
  v_mfma_f32_16x16x32_bf16 v[72:75], v[124:127], v[84:87], v[72:75]
  ds_read_b64_tr_b16 v[114:115], v15 offset:30560
  v_mfma_f32_16x16x32_bf16 v[72:75], v[120:123], v[80:83], v[72:75]
  ds_read_b64_tr_b16 v[116:117], v15 offset:43104
  s_waitcnt lgkmcnt(14)
  v_mfma_f32_16x16x32_bf16 v[24:27], v[128:131], v[96:99], v[24:27]
  ds_read_b64_tr_b16 v[118:119], v15 offset:44896
  s_waitcnt lgkmcnt(13)
  v_mfma_f32_16x16x32_bf16 v[24:27], v[132:135], v[100:103], v[24:27]
  ds_read_b64_tr_b16 v[120:121], v14 offset:28800
  v_mfma_f32_16x16x32_bf16 v[28:31], v[132:135], v[108:111], v[28:31]
  ds_read_b64_tr_b16 v[122:123], v14 offset:30592
  s_waitcnt lgkmcnt(11)
  v_mfma_f32_16x16x32_bf16 v[28:31], v[128:131], v[104:107], v[28:31]
  ds_read_b64_tr_b16 v[124:125], v14 offset:43136
  v_mfma_f32_16x16x32_bf16 v[36:39], v[136:139], v[104:107], v[36:39]
  ds_read_b64_tr_b16 v[126:127], v14 offset:44928
  s_waitcnt lgkmcnt(12)
  v_mfma_f32_16x16x32_bf16 v[36:39], v[140:143], v[108:111], v[36:39]
  ds_read_b64_tr_b16 v[128:129], v15 offset:28832
  v_mfma_f32_16x16x32_bf16 v[32:35], v[140:143], v[100:103], v[32:35]
  ds_read_b64_tr_b16 v[130:131], v15 offset:30624
  v_mfma_f32_16x16x32_bf16 v[32:35], v[136:139], v[96:99], v[32:35]
  ds_read_b64_tr_b16 v[132:133], v15 offset:43168
  s_waitcnt lgkmcnt(13)
  v_mfma_f32_16x16x32_bf16 v[40:43], v[144:147], v[96:99], v[40:43]
  ds_read_b64_tr_b16 v[134:135], v15 offset:44960
  s_waitcnt lgkmcnt(12)
  v_mfma_f32_16x16x32_bf16 v[40:43], v[148:151], v[100:103], v[40:43]
  ds_read_b64_tr_b16 v[136:137], v14 offset:28864
  v_mfma_f32_16x16x32_bf16 v[44:47], v[148:151], v[108:111], v[44:47]
  ds_read_b64_tr_b16 v[138:139], v14 offset:30656
  v_mfma_f32_16x16x32_bf16 v[44:47], v[144:147], v[104:107], v[44:47]
  ds_read_b64_tr_b16 v[140:141], v14 offset:43200
  s_waitcnt lgkmcnt(13)
  v_mfma_f32_16x16x32_bf16 v[52:55], v[112:115], v[104:107], v[52:55]
  ds_read_b64_tr_b16 v[142:143], v14 offset:44992
  s_waitcnt lgkmcnt(12)
  v_mfma_f32_16x16x32_bf16 v[52:55], v[116:119], v[108:111], v[52:55]
  ds_read_b128 v[88:91], v8 offset:19456
  v_mfma_f32_16x16x32_bf16 v[48:51], v[116:119], v[100:103], v[48:51]
  ds_read_b128 v[92:95], v9 offset:24064
  v_mfma_f32_16x16x32_bf16 v[48:51], v[112:115], v[96:99], v[48:51]
  ds_read_b128 v[84:87], v9 offset:23040
  s_waitcnt lgkmcnt(3)
  s_barrier
  v_mfma_f32_16x16x32_bf16 v[56:59], v[120:123], v[96:99], v[56:59]
  ds_read_b64_tr_b16 v[144:145], v16 offset:0
  ds_read_b64_tr_b16 v[146:147], v16 offset:1792
  v_mfma_f32_16x16x32_bf16 v[56:59], v[124:127], v[100:103], v[56:59]
  ds_read_b64_tr_b16 v[148:149], v16 offset:14336
  ds_read_b64_tr_b16 v[150:151], v16 offset:16128
  v_mfma_f32_16x16x32_bf16 v[60:63], v[124:127], v[108:111], v[60:63]
  ds_read_b64_tr_b16 v[112:113], v17 offset:32
  ds_read_b64_tr_b16 v[114:115], v17 offset:1824
  v_mfma_f32_16x16x32_bf16 v[60:63], v[120:123], v[104:107], v[60:63]
  ds_read_b64_tr_b16 v[116:117], v17 offset:14368
  ds_read_b128 v[80:83], v8 offset:18432
  v_mfma_f32_16x16x32_bf16 v[68:71], v[128:131], v[104:107], v[68:71]
  ds_read_b64_tr_b16 v[118:119], v17 offset:16160
  v_mfma_f32_16x16x32_bf16 v[68:71], v[132:135], v[108:111], v[68:71]
  ds_read_b64_tr_b16 v[120:121], v16 offset:64
  v_mfma_f32_16x16x32_bf16 v[64:67], v[132:135], v[100:103], v[64:67]
  ds_read_b64_tr_b16 v[122:123], v16 offset:1856
  v_mfma_f32_16x16x32_bf16 v[64:67], v[128:131], v[96:99], v[64:67]
  ds_read_b64_tr_b16 v[124:125], v16 offset:14400
  v_mfma_f32_16x16x32_bf16 v[72:75], v[136:139], v[96:99], v[72:75]
  ds_read_b64_tr_b16 v[126:127], v16 offset:16192
  v_mfma_f32_16x16x32_bf16 v[72:75], v[140:143], v[100:103], v[72:75]
  ds_read_b64_tr_b16 v[128:129], v17 offset:96
  v_mfma_f32_16x16x32_bf16 v[76:79], v[140:143], v[108:111], v[76:79]
  ds_read_b64_tr_b16 v[130:131], v17 offset:1888
  v_mfma_f32_16x16x32_bf16 v[76:79], v[136:139], v[104:107], v[76:79]
  ds_read_b64_tr_b16 v[132:133], v17 offset:14432
  s_waitcnt lgkmcnt(14)
  v_mfma_f32_16x16x32_bf16 v[28:31], v[144:147], v[88:91], v[28:31]
  ds_read_b64_tr_b16 v[134:135], v17 offset:16224
  s_waitcnt lgkmcnt(13)
  v_mfma_f32_16x16x32_bf16 v[28:31], v[148:151], v[92:95], v[28:31]
  ds_read_b64_tr_b16 v[136:137], v16 offset:128
  v_mfma_f32_16x16x32_bf16 v[24:27], v[148:151], v[84:87], v[24:27]
  ds_read_b64_tr_b16 v[138:139], v16 offset:1920
  s_waitcnt lgkmcnt(11)
  v_mfma_f32_16x16x32_bf16 v[24:27], v[144:147], v[80:83], v[24:27]
  ds_read_b64_tr_b16 v[140:141], v16 offset:14464
  v_mfma_f32_16x16x32_bf16 v[32:35], v[112:115], v[80:83], v[32:35]
  ds_read_b64_tr_b16 v[142:143], v16 offset:16256
  s_waitcnt lgkmcnt(12)
  v_mfma_f32_16x16x32_bf16 v[32:35], v[116:119], v[84:87], v[32:35]
  ds_read_b64_tr_b16 v[144:145], v17 offset:160
  v_mfma_f32_16x16x32_bf16 v[36:39], v[116:119], v[92:95], v[36:39]
  ds_read_b64_tr_b16 v[146:147], v17 offset:1952
  v_mfma_f32_16x16x32_bf16 v[36:39], v[112:115], v[88:91], v[36:39]
  ds_read_b64_tr_b16 v[148:149], v17 offset:14496
  s_waitcnt lgkmcnt(13)
  v_mfma_f32_16x16x32_bf16 v[44:47], v[120:123], v[88:91], v[44:47]
  ds_read_b64_tr_b16 v[150:151], v17 offset:16288
  s_waitcnt lgkmcnt(12)
  v_mfma_f32_16x16x32_bf16 v[44:47], v[124:127], v[92:95], v[44:47]
  ds_read_b64_tr_b16 v[112:113], v16 offset:192
  v_mfma_f32_16x16x32_bf16 v[40:43], v[124:127], v[84:87], v[40:43]
  ds_read_b64_tr_b16 v[114:115], v16 offset:1984
  v_mfma_f32_16x16x32_bf16 v[40:43], v[120:123], v[80:83], v[40:43]
  ds_read_b64_tr_b16 v[116:117], v16 offset:14528
  s_waitcnt lgkmcnt(13)
  v_mfma_f32_16x16x32_bf16 v[48:51], v[128:131], v[80:83], v[48:51]
  ds_read_b64_tr_b16 v[118:119], v16 offset:16320
  s_waitcnt lgkmcnt(12)
  v_mfma_f32_16x16x32_bf16 v[48:51], v[132:135], v[84:87], v[48:51]
  ds_read_b128 v[96:99], v8 offset:27648
  v_mfma_f32_16x16x32_bf16 v[52:55], v[132:135], v[92:95], v[52:55]
  ds_read_b128 v[100:103], v9 offset:32256
  v_mfma_f32_16x16x32_bf16 v[52:55], v[128:131], v[88:91], v[52:55]
  ds_read_b128 v[108:111], v9 offset:33280
  s_waitcnt lgkmcnt(3)
  s_barrier
  v_mfma_f32_16x16x32_bf16 v[60:63], v[136:139], v[88:91], v[60:63]
  ds_read_b64_tr_b16 v[120:121], v14 offset:0
  ds_read_b64_tr_b16 v[122:123], v14 offset:1792
  v_mfma_f32_16x16x32_bf16 v[60:63], v[140:143], v[92:95], v[60:63]
  ds_read_b64_tr_b16 v[124:125], v14 offset:14336
  ds_read_b64_tr_b16 v[126:127], v14 offset:16128
  v_mfma_f32_16x16x32_bf16 v[56:59], v[140:143], v[84:87], v[56:59]
  ds_read_b64_tr_b16 v[128:129], v15 offset:32
  ds_read_b64_tr_b16 v[130:131], v15 offset:1824
  v_mfma_f32_16x16x32_bf16 v[56:59], v[136:139], v[80:83], v[56:59]
  ds_read_b64_tr_b16 v[132:133], v15 offset:14368
  ds_read_b128 v[104:107], v8 offset:28672
  v_mfma_f32_16x16x32_bf16 v[64:67], v[144:147], v[80:83], v[64:67]
  ds_read_b64_tr_b16 v[134:135], v15 offset:16160
  v_mfma_f32_16x16x32_bf16 v[64:67], v[148:151], v[84:87], v[64:67]
  ds_read_b64_tr_b16 v[136:137], v14 offset:64
  v_mfma_f32_16x16x32_bf16 v[68:71], v[148:151], v[92:95], v[68:71]
  ds_read_b64_tr_b16 v[138:139], v14 offset:1856
  v_mfma_f32_16x16x32_bf16 v[68:71], v[144:147], v[88:91], v[68:71]
  ds_read_b64_tr_b16 v[140:141], v14 offset:14400
  v_mfma_f32_16x16x32_bf16 v[76:79], v[112:115], v[88:91], v[76:79]
  ds_read_b64_tr_b16 v[142:143], v14 offset:16192
  v_mfma_f32_16x16x32_bf16 v[76:79], v[116:119], v[92:95], v[76:79]
  ds_read_b64_tr_b16 v[144:145], v15 offset:96
  v_mfma_f32_16x16x32_bf16 v[72:75], v[116:119], v[84:87], v[72:75]
  ds_read_b64_tr_b16 v[146:147], v15 offset:1888
  v_mfma_f32_16x16x32_bf16 v[72:75], v[112:115], v[80:83], v[72:75]
  ds_read_b64_tr_b16 v[148:149], v15 offset:14432
  s_waitcnt lgkmcnt(14)
  v_mfma_f32_16x16x32_bf16 v[24:27], v[120:123], v[96:99], v[24:27]
  ds_read_b64_tr_b16 v[150:151], v15 offset:16224
  s_waitcnt lgkmcnt(13)
  v_mfma_f32_16x16x32_bf16 v[24:27], v[124:127], v[100:103], v[24:27]
  ds_read_b64_tr_b16 v[112:113], v14 offset:128
  v_mfma_f32_16x16x32_bf16 v[28:31], v[124:127], v[108:111], v[28:31]
  ds_read_b64_tr_b16 v[114:115], v14 offset:1920
  s_waitcnt lgkmcnt(11)
  v_mfma_f32_16x16x32_bf16 v[28:31], v[120:123], v[104:107], v[28:31]
  ds_read_b64_tr_b16 v[116:117], v14 offset:14464
  v_mfma_f32_16x16x32_bf16 v[36:39], v[128:131], v[104:107], v[36:39]
  ds_read_b64_tr_b16 v[118:119], v14 offset:16256
  s_waitcnt lgkmcnt(12)
  v_mfma_f32_16x16x32_bf16 v[36:39], v[132:135], v[108:111], v[36:39]
  ds_read_b64_tr_b16 v[120:121], v15 offset:160
  v_mfma_f32_16x16x32_bf16 v[32:35], v[132:135], v[100:103], v[32:35]
  ds_read_b64_tr_b16 v[122:123], v15 offset:1952
  v_mfma_f32_16x16x32_bf16 v[32:35], v[128:131], v[96:99], v[32:35]
  ds_read_b64_tr_b16 v[124:125], v15 offset:14496
  s_waitcnt lgkmcnt(13)
  v_mfma_f32_16x16x32_bf16 v[40:43], v[136:139], v[96:99], v[40:43]
  ds_read_b64_tr_b16 v[126:127], v15 offset:16288
  s_waitcnt lgkmcnt(12)
  v_mfma_f32_16x16x32_bf16 v[40:43], v[140:143], v[100:103], v[40:43]
  ds_read_b64_tr_b16 v[128:129], v14 offset:192
  v_mfma_f32_16x16x32_bf16 v[44:47], v[140:143], v[108:111], v[44:47]
  ds_read_b64_tr_b16 v[130:131], v14 offset:1984
  v_mfma_f32_16x16x32_bf16 v[44:47], v[136:139], v[104:107], v[44:47]
  ds_read_b64_tr_b16 v[132:133], v14 offset:14528
  s_waitcnt lgkmcnt(13)
  v_mfma_f32_16x16x32_bf16 v[52:55], v[144:147], v[104:107], v[52:55]
  ds_read_b64_tr_b16 v[134:135], v14 offset:16320
  s_waitcnt lgkmcnt(12)
  v_mfma_f32_16x16x32_bf16 v[52:55], v[148:151], v[108:111], v[52:55]
  ds_read_b128 v[88:91], v8 offset:37888
  v_mfma_f32_16x16x32_bf16 v[48:51], v[148:151], v[100:103], v[48:51]
  ds_read_b128 v[92:95], v9 offset:42496
  v_mfma_f32_16x16x32_bf16 v[48:51], v[144:147], v[96:99], v[48:51]
  ds_read_b128 v[84:87], v9 offset:41472
  s_waitcnt lgkmcnt(3)
  s_barrier
  v_mfma_f32_16x16x32_bf16 v[56:59], v[112:115], v[96:99], v[56:59]
  ds_read_b64_tr_b16 v[136:137], v14 offset:28672
  ds_read_b64_tr_b16 v[138:139], v14 offset:30464
  v_mfma_f32_16x16x32_bf16 v[56:59], v[116:119], v[100:103], v[56:59]
  ds_read_b64_tr_b16 v[140:141], v14 offset:43008
  ds_read_b64_tr_b16 v[142:143], v14 offset:44800
  v_mfma_f32_16x16x32_bf16 v[60:63], v[116:119], v[108:111], v[60:63]
  ds_read_b64_tr_b16 v[144:145], v15 offset:28704
  ds_read_b64_tr_b16 v[146:147], v15 offset:30496
  v_mfma_f32_16x16x32_bf16 v[60:63], v[112:115], v[104:107], v[60:63]
  ds_read_b64_tr_b16 v[148:149], v15 offset:43040
  ds_read_b128 v[80:83], v8 offset:36864
  v_mfma_f32_16x16x32_bf16 v[68:71], v[120:123], v[104:107], v[68:71]
  ds_read_b64_tr_b16 v[150:151], v15 offset:44832
  v_mfma_f32_16x16x32_bf16 v[68:71], v[124:127], v[108:111], v[68:71]
  ds_read_b64_tr_b16 v[112:113], v14 offset:28736
  v_mfma_f32_16x16x32_bf16 v[64:67], v[124:127], v[100:103], v[64:67]
  ds_read_b64_tr_b16 v[114:115], v14 offset:30528
  v_mfma_f32_16x16x32_bf16 v[64:67], v[120:123], v[96:99], v[64:67]
  ds_read_b64_tr_b16 v[116:117], v14 offset:43072
  v_mfma_f32_16x16x32_bf16 v[72:75], v[128:131], v[96:99], v[72:75]
  ds_read_b64_tr_b16 v[118:119], v14 offset:44864
  v_mfma_f32_16x16x32_bf16 v[72:75], v[132:135], v[100:103], v[72:75]
  ds_read_b64_tr_b16 v[120:121], v15 offset:28768
  v_mfma_f32_16x16x32_bf16 v[76:79], v[132:135], v[108:111], v[76:79]
  ds_read_b64_tr_b16 v[122:123], v15 offset:30560
  v_mfma_f32_16x16x32_bf16 v[76:79], v[128:131], v[104:107], v[76:79]
  ds_read_b64_tr_b16 v[124:125], v15 offset:43104
  s_waitcnt lgkmcnt(14)
  v_mfma_f32_16x16x32_bf16 v[28:31], v[136:139], v[88:91], v[28:31]
  ds_read_b64_tr_b16 v[126:127], v15 offset:44896
  s_waitcnt lgkmcnt(13)
  v_mfma_f32_16x16x32_bf16 v[28:31], v[140:143], v[92:95], v[28:31]
  ds_read_b64_tr_b16 v[128:129], v14 offset:28800
  v_mfma_f32_16x16x32_bf16 v[24:27], v[140:143], v[84:87], v[24:27]
  ds_read_b64_tr_b16 v[130:131], v14 offset:30592
  s_waitcnt lgkmcnt(11)
  v_mfma_f32_16x16x32_bf16 v[24:27], v[136:139], v[80:83], v[24:27]
  ds_read_b64_tr_b16 v[132:133], v14 offset:43136
  v_mfma_f32_16x16x32_bf16 v[32:35], v[144:147], v[80:83], v[32:35]
  ds_read_b64_tr_b16 v[134:135], v14 offset:44928
  s_waitcnt lgkmcnt(12)
  v_mfma_f32_16x16x32_bf16 v[32:35], v[148:151], v[84:87], v[32:35]
  ds_read_b64_tr_b16 v[136:137], v15 offset:28832
  v_mfma_f32_16x16x32_bf16 v[36:39], v[148:151], v[92:95], v[36:39]
  ds_read_b64_tr_b16 v[138:139], v15 offset:30624
  v_mfma_f32_16x16x32_bf16 v[36:39], v[144:147], v[88:91], v[36:39]
  ds_read_b64_tr_b16 v[140:141], v15 offset:43168
  s_waitcnt lgkmcnt(13)
  v_mfma_f32_16x16x32_bf16 v[44:47], v[112:115], v[88:91], v[44:47]
  ds_read_b64_tr_b16 v[142:143], v15 offset:44960
  s_waitcnt lgkmcnt(12)
  v_mfma_f32_16x16x32_bf16 v[44:47], v[116:119], v[92:95], v[44:47]
  ds_read_b64_tr_b16 v[144:145], v14 offset:28864
  v_mfma_f32_16x16x32_bf16 v[40:43], v[116:119], v[84:87], v[40:43]
  ds_read_b64_tr_b16 v[146:147], v14 offset:30656
  v_mfma_f32_16x16x32_bf16 v[40:43], v[112:115], v[80:83], v[40:43]
  ds_read_b64_tr_b16 v[148:149], v14 offset:43200
  s_waitcnt lgkmcnt(13)
  v_mfma_f32_16x16x32_bf16 v[48:51], v[120:123], v[80:83], v[48:51]
  ds_read_b64_tr_b16 v[150:151], v14 offset:44992
  s_waitcnt lgkmcnt(12)
  v_mfma_f32_16x16x32_bf16 v[48:51], v[124:127], v[84:87], v[48:51]
  ds_read_b128 v[96:99], v8 offset:46080
  v_mfma_f32_16x16x32_bf16 v[52:55], v[124:127], v[92:95], v[52:55]
  ds_read_b128 v[100:103], v9 offset:50688
  v_mfma_f32_16x16x32_bf16 v[52:55], v[120:123], v[88:91], v[52:55]
  ds_read_b128 v[108:111], v9 offset:51712
  s_waitcnt lgkmcnt(3)
  s_barrier
  v_mfma_f32_16x16x32_bf16 v[60:63], v[128:131], v[88:91], v[60:63]
  ds_read_b64_tr_b16 v[112:113], v16 offset:0
  ds_read_b64_tr_b16 v[114:115], v16 offset:1792
  v_mfma_f32_16x16x32_bf16 v[60:63], v[132:135], v[92:95], v[60:63]
  ds_read_b64_tr_b16 v[116:117], v16 offset:14336
  ds_read_b64_tr_b16 v[118:119], v16 offset:16128
  v_mfma_f32_16x16x32_bf16 v[56:59], v[132:135], v[84:87], v[56:59]
  ds_read_b64_tr_b16 v[120:121], v17 offset:32
  ds_read_b64_tr_b16 v[122:123], v17 offset:1824
  v_mfma_f32_16x16x32_bf16 v[56:59], v[128:131], v[80:83], v[56:59]
  ds_read_b64_tr_b16 v[124:125], v17 offset:14368
  ds_read_b128 v[104:107], v8 offset:47104
  v_mfma_f32_16x16x32_bf16 v[64:67], v[136:139], v[80:83], v[64:67]
  ds_read_b64_tr_b16 v[126:127], v17 offset:16160
  v_mfma_f32_16x16x32_bf16 v[64:67], v[140:143], v[84:87], v[64:67]
  ds_read_b64_tr_b16 v[128:129], v16 offset:64
  v_mfma_f32_16x16x32_bf16 v[68:71], v[140:143], v[92:95], v[68:71]
  ds_read_b64_tr_b16 v[130:131], v16 offset:1856
  v_mfma_f32_16x16x32_bf16 v[68:71], v[136:139], v[88:91], v[68:71]
  ds_read_b64_tr_b16 v[132:133], v16 offset:14400
  v_mfma_f32_16x16x32_bf16 v[76:79], v[144:147], v[88:91], v[76:79]
  ds_read_b64_tr_b16 v[134:135], v16 offset:16192
  v_mfma_f32_16x16x32_bf16 v[76:79], v[148:151], v[92:95], v[76:79]
  ds_read_b64_tr_b16 v[136:137], v17 offset:96
  v_mfma_f32_16x16x32_bf16 v[72:75], v[148:151], v[84:87], v[72:75]
  ds_read_b64_tr_b16 v[138:139], v17 offset:1888
  v_mfma_f32_16x16x32_bf16 v[72:75], v[144:147], v[80:83], v[72:75]
  ds_read_b64_tr_b16 v[140:141], v17 offset:14432
  s_waitcnt lgkmcnt(14)
  v_mfma_f32_16x16x32_bf16 v[24:27], v[112:115], v[96:99], v[24:27]
  ds_read_b64_tr_b16 v[142:143], v17 offset:16224
  s_waitcnt lgkmcnt(13)
  v_mfma_f32_16x16x32_bf16 v[24:27], v[116:119], v[100:103], v[24:27]
  ds_read_b64_tr_b16 v[144:145], v16 offset:128
  v_mfma_f32_16x16x32_bf16 v[28:31], v[116:119], v[108:111], v[28:31]
  ds_read_b64_tr_b16 v[146:147], v16 offset:1920
  s_waitcnt lgkmcnt(11)
  v_mfma_f32_16x16x32_bf16 v[28:31], v[112:115], v[104:107], v[28:31]
  ds_read_b64_tr_b16 v[148:149], v16 offset:14464
  v_mfma_f32_16x16x32_bf16 v[36:39], v[120:123], v[104:107], v[36:39]
  ds_read_b64_tr_b16 v[150:151], v16 offset:16256
  s_waitcnt lgkmcnt(12)
  v_mfma_f32_16x16x32_bf16 v[36:39], v[124:127], v[108:111], v[36:39]
  ds_read_b64_tr_b16 v[112:113], v17 offset:160
  v_mfma_f32_16x16x32_bf16 v[32:35], v[124:127], v[100:103], v[32:35]
  ds_read_b64_tr_b16 v[114:115], v17 offset:1952
  v_mfma_f32_16x16x32_bf16 v[32:35], v[120:123], v[96:99], v[32:35]
  ds_read_b64_tr_b16 v[116:117], v17 offset:14496
  s_waitcnt lgkmcnt(13)
  v_mfma_f32_16x16x32_bf16 v[40:43], v[128:131], v[96:99], v[40:43]
  ds_read_b64_tr_b16 v[118:119], v17 offset:16288
  s_waitcnt lgkmcnt(12)
  v_mfma_f32_16x16x32_bf16 v[40:43], v[132:135], v[100:103], v[40:43]
  ds_read_b64_tr_b16 v[120:121], v16 offset:192
  v_mfma_f32_16x16x32_bf16 v[44:47], v[132:135], v[108:111], v[44:47]
  ds_read_b64_tr_b16 v[122:123], v16 offset:1984
  v_mfma_f32_16x16x32_bf16 v[44:47], v[128:131], v[104:107], v[44:47]
  ds_read_b64_tr_b16 v[124:125], v16 offset:14528
  s_waitcnt lgkmcnt(13)
  v_mfma_f32_16x16x32_bf16 v[52:55], v[136:139], v[104:107], v[52:55]
  ds_read_b64_tr_b16 v[126:127], v16 offset:16320
  s_waitcnt lgkmcnt(12)
  v_mfma_f32_16x16x32_bf16 v[52:55], v[140:143], v[108:111], v[52:55]
  ds_read_b128 v[88:91], v8 offset:56320
  v_mfma_f32_16x16x32_bf16 v[48:51], v[140:143], v[100:103], v[48:51]
  ds_read_b128 v[92:95], v9 offset:60928
  v_mfma_f32_16x16x32_bf16 v[48:51], v[136:139], v[96:99], v[48:51]
  ds_read_b128 v[84:87], v9 offset:59904
  s_waitcnt lgkmcnt(3)
  s_barrier
  v_mfma_f32_16x16x32_bf16 v[56:59], v[144:147], v[96:99], v[56:59]
  ds_read_b64_tr_b16 v[128:129], v14 offset:0
  ds_read_b64_tr_b16 v[130:131], v14 offset:1792
  v_mfma_f32_16x16x32_bf16 v[56:59], v[148:151], v[100:103], v[56:59]
  ds_read_b64_tr_b16 v[132:133], v14 offset:14336
  ds_read_b64_tr_b16 v[134:135], v14 offset:16128
  v_mfma_f32_16x16x32_bf16 v[60:63], v[148:151], v[108:111], v[60:63]
  ds_read_b64_tr_b16 v[136:137], v15 offset:32
  ds_read_b64_tr_b16 v[138:139], v15 offset:1824
  v_mfma_f32_16x16x32_bf16 v[60:63], v[144:147], v[104:107], v[60:63]
  ds_read_b64_tr_b16 v[140:141], v15 offset:14368
  ds_read_b128 v[80:83], v8 offset:55296
  v_mfma_f32_16x16x32_bf16 v[68:71], v[112:115], v[104:107], v[68:71]
  ds_read_b64_tr_b16 v[142:143], v15 offset:16160
  v_mfma_f32_16x16x32_bf16 v[68:71], v[116:119], v[108:111], v[68:71]
  ds_read_b64_tr_b16 v[144:145], v14 offset:64
  v_mfma_f32_16x16x32_bf16 v[64:67], v[116:119], v[100:103], v[64:67]
  ds_read_b64_tr_b16 v[146:147], v14 offset:1856
  v_mfma_f32_16x16x32_bf16 v[64:67], v[112:115], v[96:99], v[64:67]
  ds_read_b64_tr_b16 v[148:149], v14 offset:14400
  v_mfma_f32_16x16x32_bf16 v[72:75], v[120:123], v[96:99], v[72:75]
  ds_read_b64_tr_b16 v[150:151], v14 offset:16192
  v_mfma_f32_16x16x32_bf16 v[72:75], v[124:127], v[100:103], v[72:75]
  ds_read_b64_tr_b16 v[112:113], v15 offset:96
  v_mfma_f32_16x16x32_bf16 v[76:79], v[124:127], v[108:111], v[76:79]
  ds_read_b64_tr_b16 v[114:115], v15 offset:1888
  v_mfma_f32_16x16x32_bf16 v[76:79], v[120:123], v[104:107], v[76:79]
  ds_read_b64_tr_b16 v[116:117], v15 offset:14432
  s_waitcnt lgkmcnt(14)
  v_mfma_f32_16x16x32_bf16 v[28:31], v[128:131], v[88:91], v[28:31]
  ds_read_b64_tr_b16 v[118:119], v15 offset:16224
  s_waitcnt lgkmcnt(13)
  v_mfma_f32_16x16x32_bf16 v[28:31], v[132:135], v[92:95], v[28:31]
  ds_read_b64_tr_b16 v[120:121], v14 offset:128
  v_mfma_f32_16x16x32_bf16 v[24:27], v[132:135], v[84:87], v[24:27]
  ds_read_b64_tr_b16 v[122:123], v14 offset:1920
  s_waitcnt lgkmcnt(11)
  v_mfma_f32_16x16x32_bf16 v[24:27], v[128:131], v[80:83], v[24:27]
  ds_read_b64_tr_b16 v[124:125], v14 offset:14464
  v_mfma_f32_16x16x32_bf16 v[32:35], v[136:139], v[80:83], v[32:35]
  ds_read_b64_tr_b16 v[126:127], v14 offset:16256
  s_waitcnt lgkmcnt(12)
  v_mfma_f32_16x16x32_bf16 v[32:35], v[140:143], v[84:87], v[32:35]
  ds_read_b64_tr_b16 v[128:129], v15 offset:160
  v_mfma_f32_16x16x32_bf16 v[36:39], v[140:143], v[92:95], v[36:39]
  ds_read_b64_tr_b16 v[130:131], v15 offset:1952
  v_mfma_f32_16x16x32_bf16 v[36:39], v[136:139], v[88:91], v[36:39]
  ds_read_b64_tr_b16 v[132:133], v15 offset:14496
  s_waitcnt lgkmcnt(13)
  v_mfma_f32_16x16x32_bf16 v[44:47], v[144:147], v[88:91], v[44:47]
  ds_read_b64_tr_b16 v[134:135], v15 offset:16288
  s_waitcnt lgkmcnt(12)
  v_mfma_f32_16x16x32_bf16 v[44:47], v[148:151], v[92:95], v[44:47]
  ds_read_b64_tr_b16 v[136:137], v14 offset:192
  v_mfma_f32_16x16x32_bf16 v[40:43], v[148:151], v[84:87], v[40:43]
  ds_read_b64_tr_b16 v[138:139], v14 offset:1984
  v_mfma_f32_16x16x32_bf16 v[40:43], v[144:147], v[80:83], v[40:43]
  ds_read_b64_tr_b16 v[140:141], v14 offset:14528
  s_waitcnt lgkmcnt(13)
  v_mfma_f32_16x16x32_bf16 v[48:51], v[112:115], v[80:83], v[48:51]
  ds_read_b64_tr_b16 v[142:143], v14 offset:16320
  s_waitcnt lgkmcnt(12)
  v_mfma_f32_16x16x32_bf16 v[48:51], v[116:119], v[84:87], v[48:51]
  v_mfma_f32_16x16x32_bf16 v[52:55], v[116:119], v[92:95], v[52:55]
  v_mfma_f32_16x16x32_bf16 v[52:55], v[112:115], v[88:91], v[52:55]
  s_waitcnt lgkmcnt(0)
  s_barrier
  v_mfma_f32_16x16x32_bf16 v[60:63], v[120:123], v[88:91], v[60:63]
  v_mfma_f32_16x16x32_bf16 v[60:63], v[124:127], v[92:95], v[60:63]
  v_mfma_f32_16x16x32_bf16 v[56:59], v[124:127], v[84:87], v[56:59]
  v_mfma_f32_16x16x32_bf16 v[56:59], v[120:123], v[80:83], v[56:59]
  v_mfma_f32_16x16x32_bf16 v[64:67], v[128:131], v[80:83], v[64:67]
  v_mfma_f32_16x16x32_bf16 v[64:67], v[132:135], v[84:87], v[64:67]
  v_mfma_f32_16x16x32_bf16 v[68:71], v[132:135], v[92:95], v[68:71]
  v_mfma_f32_16x16x32_bf16 v[68:71], v[128:131], v[88:91], v[68:71]
  v_mfma_f32_16x16x32_bf16 v[76:79], v[136:139], v[88:91], v[76:79]
  v_mfma_f32_16x16x32_bf16 v[76:79], v[140:143], v[92:95], v[76:79]
  v_mfma_f32_16x16x32_bf16 v[72:75], v[140:143], v[84:87], v[72:75]
  v_mfma_f32_16x16x32_bf16 v[72:75], v[136:139], v[80:83], v[72:75]
  s_setprio 2
  s_lshl_b32 s76, s73, 3
  s_mul_i32 s77, s73, 12288
  v_add_u32 v14, s76, v3
  v_add_u32 v15, s77, v3
  v_fma_f32 v108, -v24, v24, s85
  v_fma_f32 v109, -v25, v25, s85
  v_fma_f32 v110, -v26, v26, s85
  v_fma_f32 v111, -v27, v27, s85
  v_fma_f32 v112, -v28, v28, s85
  v_fma_f32 v113, -v29, v29, s85
  v_fma_f32 v114, -v30, v30, s85
  v_fma_f32 v115, -v31, v31, s85
  v_mul_f32 v108, v108, v24
  v_mul_f32 v109, v109, v25
  v_mul_f32 v110, v110, v26
  v_mul_f32 v111, v111, v27
  v_mul_f32 v112, v112, v28
  v_mul_f32 v113, v113, v29
  v_mul_f32 v114, v114, v30
  v_mul_f32 v115, v115, v31
  v_exp_f32 v108, v108
  v_exp_f32 v109, v109
  v_exp_f32 v110, v110
  v_exp_f32 v111, v111
  v_exp_f32 v112, v112
  v_exp_f32 v113, v113
  v_exp_f32 v114, v114
  v_exp_f32 v115, v115
  v_fma_f32 v108, v108, s82, s82
  v_fma_f32 v109, v109, s82, s82
  v_fma_f32 v110, v110, s82, s82
  v_fma_f32 v111, v111, s82, s82
  v_fma_f32 v112, v112, s82, s82
  v_fma_f32 v113, v113, s82, s82
  v_fma_f32 v114, v114, s82, s82
  v_fma_f32 v115, v115, s82, s82
  v_rcp_f32 v108, v108
  v_rcp_f32 v109, v109
  v_rcp_f32 v110, v110
  v_rcp_f32 v111, v111
  v_rcp_f32 v112, v112
  s_barrier
  v_rcp_f32 v113, v113
  v_rcp_f32 v114, v114
  v_rcp_f32 v115, v115
  v_mul_f32 v108, v108, v24
  v_mul_f32 v109, v109, v25
  v_mul_f32 v110, v110, v26
  v_mul_f32 v111, v111, v27
  v_mul_f32 v112, v112, v28
  v_mul_f32 v113, v113, v29
  v_mul_f32 v114, v114, v30
  v_mul_f32 v115, v115, v31
  v_cvt_pk_bf16_f32 v80, v108, v109
  v_cvt_pk_bf16_f32 v81, v110, v111
  v_cvt_pk_bf16_f32 v84, v112, v113
  v_cvt_pk_bf16_f32 v85, v114, v115
  v_fma_f32 v108, -v32, v32, s85
  v_fma_f32 v109, -v33, v33, s85
  v_fma_f32 v110, -v34, v34, s85
  v_fma_f32 v111, -v35, v35, s85
  v_fma_f32 v112, -v36, v36, s85
  v_fma_f32 v113, -v37, v37, s85
  v_fma_f32 v114, -v38, v38, s85
  v_fma_f32 v115, -v39, v39, s85
  v_mul_f32 v108, v108, v32
  v_mul_f32 v109, v109, v33
  v_mul_f32 v110, v110, v34
  v_mul_f32 v111, v111, v35
  v_mul_f32 v112, v112, v36
  v_mul_f32 v113, v113, v37
  v_mul_f32 v114, v114, v38
  v_mul_f32 v115, v115, v39
  v_exp_f32 v108, v108
  v_exp_f32 v109, v109
  v_exp_f32 v110, v110
  v_exp_f32 v111, v111
  v_exp_f32 v112, v112
  v_exp_f32 v113, v113
  v_exp_f32 v114, v114
  v_exp_f32 v115, v115
  v_fma_f32 v108, v108, s82, s82
  v_fma_f32 v109, v109, s82, s82
  v_fma_f32 v110, v110, s82, s82
  v_fma_f32 v111, v111, s82, s82
  v_fma_f32 v112, v112, s82, s82
  v_fma_f32 v113, v113, s82, s82
  v_fma_f32 v114, v114, s82, s82
  v_fma_f32 v115, v115, s82, s82
  v_rcp_f32 v108, v108
  v_rcp_f32 v109, v109
  v_rcp_f32 v110, v110
  v_rcp_f32 v111, v111
  v_rcp_f32 v112, v112
  v_rcp_f32 v113, v113
  s_barrier
  v_rcp_f32 v114, v114
  v_rcp_f32 v115, v115
  v_mul_f32 v108, v108, v32
  v_mul_f32 v109, v109, v33
  v_mul_f32 v110, v110, v34
  v_mul_f32 v111, v111, v35
  v_mul_f32 v112, v112, v36
  v_mul_f32 v113, v113, v37
  v_mul_f32 v114, v114, v38
  v_mul_f32 v115, v115, v39
  v_cvt_pk_bf16_f32 v82, v108, v109
  v_cvt_pk_bf16_f32 v83, v110, v111
  v_cvt_pk_bf16_f32 v86, v112, v113
  v_cvt_pk_bf16_f32 v87, v114, v115
  v_fma_f32 v108, -v40, v40, s85
  v_fma_f32 v109, -v41, v41, s85
  v_fma_f32 v110, -v42, v42, s85
  v_fma_f32 v111, -v43, v43, s85
  v_fma_f32 v112, -v44, v44, s85
  v_fma_f32 v113, -v45, v45, s85
  v_fma_f32 v114, -v46, v46, s85
  v_fma_f32 v115, -v47, v47, s85
  v_mul_f32 v108, v108, v40
  v_mul_f32 v109, v109, v41
  v_mul_f32 v110, v110, v42
  v_mul_f32 v111, v111, v43
  v_mul_f32 v112, v112, v44
  v_mul_f32 v113, v113, v45
  v_mul_f32 v114, v114, v46
  v_mul_f32 v115, v115, v47
  v_exp_f32 v108, v108
  v_exp_f32 v109, v109
  v_exp_f32 v110, v110
  v_exp_f32 v111, v111
  v_exp_f32 v112, v112
  v_exp_f32 v113, v113
  v_exp_f32 v114, v114
  v_exp_f32 v115, v115
  v_fma_f32 v108, v108, s82, s82
  v_fma_f32 v109, v109, s82, s82
  v_fma_f32 v110, v110, s82, s82
  v_fma_f32 v111, v111, s82, s82
  v_fma_f32 v112, v112, s82, s82
  v_fma_f32 v113, v113, s82, s82
  v_fma_f32 v114, v114, s82, s82
  v_fma_f32 v115, v115, s82, s82
  v_rcp_f32 v108, v108
  v_rcp_f32 v109, v109
  v_rcp_f32 v110, v110
  v_rcp_f32 v111, v111
  v_rcp_f32 v112, v112
  v_rcp_f32 v113, v113
  v_rcp_f32 v114, v114
  v_rcp_f32 v115, v115
  s_barrier
  v_mul_f32 v108, v108, v40
  v_mul_f32 v109, v109, v41
  v_mul_f32 v110, v110, v42
  v_mul_f32 v111, v111, v43
  v_mul_f32 v112, v112, v44
  v_mul_f32 v113, v113, v45
  v_mul_f32 v114, v114, v46
  v_mul_f32 v115, v115, v47
  v_cvt_pk_bf16_f32 v88, v108, v109
  v_cvt_pk_bf16_f32 v89, v110, v111
  v_cvt_pk_bf16_f32 v92, v112, v113
  v_cvt_pk_bf16_f32 v93, v114, v115
  v_fma_f32 v108, -v48, v48, s85
  v_fma_f32 v109, -v49, v49, s85
  v_fma_f32 v110, -v50, v50, s85
  v_fma_f32 v111, -v51, v51, s85
  v_fma_f32 v112, -v52, v52, s85
  v_fma_f32 v113, -v53, v53, s85
  v_fma_f32 v114, -v54, v54, s85
  v_fma_f32 v115, -v55, v55, s85
  v_mul_f32 v108, v108, v48
  v_mul_f32 v109, v109, v49
  v_mul_f32 v110, v110, v50
  v_mul_f32 v111, v111, v51
  v_mul_f32 v112, v112, v52
  v_mul_f32 v113, v113, v53
  v_mul_f32 v114, v114, v54
  v_mul_f32 v115, v115, v55
  v_exp_f32 v108, v108
  v_exp_f32 v109, v109
  v_exp_f32 v110, v110
  v_exp_f32 v111, v111
  v_exp_f32 v112, v112
  v_exp_f32 v113, v113
  v_exp_f32 v114, v114
  v_exp_f32 v115, v115
  v_fma_f32 v108, v108, s82, s82
  v_fma_f32 v109, v109, s82, s82
  v_fma_f32 v110, v110, s82, s82
  v_fma_f32 v111, v111, s82, s82
  v_fma_f32 v112, v112, s82, s82
  v_fma_f32 v113, v113, s82, s82
  v_fma_f32 v114, v114, s82, s82
  v_fma_f32 v115, v115, s82, s82
  v_rcp_f32 v108, v108
  v_rcp_f32 v109, v109
  v_rcp_f32 v110, v110
  v_rcp_f32 v111, v111
  v_rcp_f32 v112, v112
  v_rcp_f32 v113, v113
  v_rcp_f32 v114, v114
  v_rcp_f32 v115, v115
  v_mul_f32 v108, v108, v48
  v_mul_f32 v109, v109, v49
  v_mul_f32 v110, v110, v50
  s_barrier
  v_mul_f32 v111, v111, v51
  v_mul_f32 v112, v112, v52
  v_mul_f32 v113, v113, v53
  v_mul_f32 v114, v114, v54
  v_mul_f32 v115, v115, v55
  v_cvt_pk_bf16_f32 v90, v108, v109
  v_cvt_pk_bf16_f32 v91, v110, v111
  v_cvt_pk_bf16_f32 v94, v112, v113
  v_cvt_pk_bf16_f32 v95, v114, v115
  v_fma_f32 v108, -v56, v56, s85
  v_fma_f32 v109, -v57, v57, s85
  v_fma_f32 v110, -v58, v58, s85
  v_fma_f32 v111, -v59, v59, s85
  v_fma_f32 v112, -v60, v60, s85
  v_fma_f32 v113, -v61, v61, s85
  v_fma_f32 v114, -v62, v62, s85
  v_fma_f32 v115, -v63, v63, s85
  v_mul_f32 v108, v108, v56
  v_mul_f32 v109, v109, v57
  v_mul_f32 v110, v110, v58
  v_mul_f32 v111, v111, v59
  v_mul_f32 v112, v112, v60
  v_mul_f32 v113, v113, v61
  v_mul_f32 v114, v114, v62
  v_mul_f32 v115, v115, v63
  v_exp_f32 v108, v108
  v_exp_f32 v109, v109
  v_exp_f32 v110, v110
  v_exp_f32 v111, v111
  v_exp_f32 v112, v112
  v_exp_f32 v113, v113
  v_exp_f32 v114, v114
  v_exp_f32 v115, v115
  v_fma_f32 v108, v108, s82, s82
  v_fma_f32 v109, v109, s82, s82
  v_fma_f32 v110, v110, s82, s82
  v_fma_f32 v111, v111, s82, s82
  v_fma_f32 v112, v112, s82, s82
  v_fma_f32 v113, v113, s82, s82
  v_fma_f32 v114, v114, s82, s82
  v_fma_f32 v115, v115, s82, s82
  v_rcp_f32 v108, v108
  v_rcp_f32 v109, v109
  v_rcp_f32 v110, v110
  v_rcp_f32 v111, v111
  v_rcp_f32 v112, v112
  v_rcp_f32 v113, v113
  v_rcp_f32 v114, v114
  v_rcp_f32 v115, v115
  v_mul_f32 v108, v108, v56
  v_mul_f32 v109, v109, v57
  v_mul_f32 v110, v110, v58
  v_mul_f32 v111, v111, v59
  v_mul_f32 v112, v112, v60
  v_mul_f32 v113, v113, v61
  s_barrier
  v_mul_f32 v114, v114, v62
  v_mul_f32 v115, v115, v63
  v_cvt_pk_bf16_f32 v96, v108, v109
  v_cvt_pk_bf16_f32 v97, v110, v111
  v_cvt_pk_bf16_f32 v100, v112, v113
  v_cvt_pk_bf16_f32 v101, v114, v115
  v_fma_f32 v108, -v64, v64, s85
  v_fma_f32 v109, -v65, v65, s85
  v_fma_f32 v110, -v66, v66, s85
  v_fma_f32 v111, -v67, v67, s85
  v_fma_f32 v112, -v68, v68, s85
  v_fma_f32 v113, -v69, v69, s85
  v_fma_f32 v114, -v70, v70, s85
  v_fma_f32 v115, -v71, v71, s85
  v_mul_f32 v108, v108, v64
  v_mul_f32 v109, v109, v65
  v_mul_f32 v110, v110, v66
  v_mul_f32 v111, v111, v67
  v_mul_f32 v112, v112, v68
  v_mul_f32 v113, v113, v69
  v_mul_f32 v114, v114, v70
  v_mul_f32 v115, v115, v71
  v_exp_f32 v108, v108
  v_exp_f32 v109, v109
  v_exp_f32 v110, v110
  v_exp_f32 v111, v111
  v_exp_f32 v112, v112
  v_exp_f32 v113, v113
  v_exp_f32 v114, v114
  v_exp_f32 v115, v115
  v_fma_f32 v108, v108, s82, s82
  v_fma_f32 v109, v109, s82, s82
  v_fma_f32 v110, v110, s82, s82
  v_fma_f32 v111, v111, s82, s82
  v_fma_f32 v112, v112, s82, s82
  v_fma_f32 v113, v113, s82, s82
  v_fma_f32 v114, v114, s82, s82
  v_fma_f32 v115, v115, s82, s82
  v_rcp_f32 v108, v108
  v_rcp_f32 v109, v109
  v_rcp_f32 v110, v110
  v_rcp_f32 v111, v111
  v_rcp_f32 v112, v112
  v_rcp_f32 v113, v113
  v_rcp_f32 v114, v114
  v_rcp_f32 v115, v115
  v_mul_f32 v108, v108, v64
  v_mul_f32 v109, v109, v65
  v_mul_f32 v110, v110, v66
  v_mul_f32 v111, v111, v67
  v_mul_f32 v112, v112, v68
  v_mul_f32 v113, v113, v69
  v_mul_f32 v114, v114, v70
  v_mul_f32 v115, v115, v71
  v_cvt_pk_bf16_f32 v98, v108, v109
  s_barrier
  v_cvt_pk_bf16_f32 v99, v110, v111
  v_cvt_pk_bf16_f32 v102, v112, v113
  v_cvt_pk_bf16_f32 v103, v114, v115
  v_fma_f32 v108, -v72, v72, s85
  v_fma_f32 v109, -v73, v73, s85
  v_fma_f32 v110, -v74, v74, s85
  v_fma_f32 v111, -v75, v75, s85
  v_fma_f32 v112, -v76, v76, s85
  v_fma_f32 v113, -v77, v77, s85
  v_fma_f32 v114, -v78, v78, s85
  v_fma_f32 v115, -v79, v79, s85
  v_mul_f32 v108, v108, v72
  v_mul_f32 v109, v109, v73
  v_mul_f32 v110, v110, v74
  v_mul_f32 v111, v111, v75
  v_mul_f32 v112, v112, v76
  v_mul_f32 v113, v113, v77
  v_mul_f32 v114, v114, v78
  v_mul_f32 v115, v115, v79
  v_exp_f32 v108, v108
  v_exp_f32 v109, v109
  v_exp_f32 v110, v110
  v_exp_f32 v111, v111
  v_exp_f32 v112, v112
  v_exp_f32 v113, v113
  v_exp_f32 v114, v114
  v_exp_f32 v115, v115
  v_fma_f32 v108, v108, s82, s82
  v_fma_f32 v109, v109, s82, s82
  v_fma_f32 v110, v110, s82, s82
  v_fma_f32 v111, v111, s82, s82
  v_fma_f32 v112, v112, s82, s82
  v_fma_f32 v113, v113, s82, s82
  v_fma_f32 v114, v114, s82, s82
  v_fma_f32 v115, v115, s82, s82
  v_rcp_f32 v108, v108
  v_rcp_f32 v109, v109
  v_rcp_f32 v110, v110
  v_rcp_f32 v111, v111
  v_rcp_f32 v112, v112
  v_rcp_f32 v113, v113
  v_rcp_f32 v114, v114
  v_rcp_f32 v115, v115
  v_mul_f32 v108, v108, v72
  v_mul_f32 v109, v109, v73
  v_mul_f32 v110, v110, v74
  v_mul_f32 v111, v111, v75
  v_mul_f32 v112, v112, v76
  v_mul_f32 v113, v113, v77
  v_mul_f32 v114, v114, v78
  v_mul_f32 v115, v115, v79
  v_cvt_pk_bf16_f32 v104, v108, v109
  v_cvt_pk_bf16_f32 v105, v110, v111
  v_cvt_pk_bf16_f32 v106, v112, v113
  v_cvt_pk_bf16_f32 v107, v114, v115
  s_barrier
  s_setprio 3
  ds_write_b128 v15, v[80:83] offset:36864
  ds_write_b128 v15, v[84:87] offset:37888
  ds_write_b128 v15, v[88:91] offset:40960
  ds_write_b128 v15, v[92:95] offset:41984
  ds_write_b128 v15, v[96:99] offset:45056
  ds_write_b128 v15, v[100:103] offset:46080
  ds_write2st64_b64 v14, v[104:105], v[106:107] offset0:120 offset1:122
  s_setprio 1
  s_waitcnt lgkmcnt(0)
  s_barrier
  ds_read_b128 v[96:99], v3 offset:36864
  ds_read_b128 v[132:135], v3 offset:37888
  ds_read_b128 v[100:103], v3 offset:40960
  ds_read_b128 v[136:139], v3 offset:41984
  ds_read_b128 v[104:107], v3 offset:45056
  ds_read_b128 v[140:143], v3 offset:46080
  ds_read_b128 v[108:111], v3 offset:49152
  ds_read_b128 v[144:147], v3 offset:50176
  ds_read_b128 v[112:115], v3 offset:53248
  ds_read_b128 v[148:151], v3 offset:54272
  ds_read_b128 v[116:119], v3 offset:57344
  ds_read_b128 v[152:155], v3 offset:58368
  ds_read_b128 v[120:123], v3 offset:61440
  ds_read_b128 v[156:159], v3 offset:62464
  ds_read_b64_tr_b16 v[44:45], v12 offset:0
  ds_read_b64_tr_b16 v[46:47], v12 offset:2048
  ds_read_b64_tr_b16 v[48:49], v12 offset:4096
  ds_read_b64_tr_b16 v[50:51], v12 offset:6144
  ds_read_b64_tr_b16 v[52:53], v12 offset:8192
  ds_read_b64_tr_b16 v[54:55], v12 offset:10240
  ds_read_b64_tr_b16 v[56:57], v12 offset:14336
  ds_read_b64_tr_b16 v[58:59], v12 offset:16384
  ds_read_b64_tr_b16 v[60:61], v12 offset:18432
  s_waitcnt lgkmcnt(7)
  v_mfma_f32_16x16x32_bf16 v[28:31], v[44:47], v[96:99], 0
  ds_read_b64_tr_b16 v[62:63], v12 offset:20480
  v_mfma_f32_16x16x32_bf16 v[32:35], v[44:47], v[132:135], 0
  ds_read_b64_tr_b16 v[64:65], v12 offset:22528
  s_waitcnt lgkmcnt(7)
  v_mfma_f32_16x16x32_bf16 v[32:35], v[48:51], v[136:139], v[32:35]
  ds_read_b64_tr_b16 v[66:67], v12 offset:24576
  v_mfma_f32_16x16x32_bf16 v[28:31], v[48:51], v[100:103], v[28:31]
  ds_read_b64_tr_b16 v[44:45], v12 offset:12288
  s_waitcnt lgkmcnt(7)
  v_mfma_f32_16x16x32_bf16 v[28:31], v[52:55], v[104:107], v[28:31]
  ds_read_b64_tr_b16 v[46:47], v12 offset:26624
  v_mfma_f32_16x16x32_bf16 v[32:35], v[52:55], v[140:143], v[32:35]
  s_waitcnt lgkmcnt(0)
  s_barrier
  v_mov_b32 v7, 161924
  ds_read_b32 v7, v7
  v_mfma_f32_16x16x32_bf16 v[32:35], v[56:59], v[144:147], v[32:35]
  ds_read_b128 v[124:127], v3 offset:0
  ds_read_b128 v[160:163], v3 offset:1024
  v_mfma_f32_16x16x32_bf16 v[28:31], v[56:59], v[108:111], v[28:31]
  ds_read_b64_tr_b16 v[48:49], v12 offset:28672
  ds_read_b64_tr_b16 v[50:51], v13 offset:30208
  v_mfma_f32_16x16x32_bf16 v[28:31], v[60:63], v[112:115], v[28:31]
  ds_read_b128 v[128:131], v3 offset:4096
  ds_read_b128 v[164:167], v3 offset:5120
  v_mfma_f32_16x16x32_bf16 v[32:35], v[60:63], v[148:151], v[32:35]
  ds_read_b64_tr_b16 v[52:53], v13 offset:32256
  ds_read_b64_tr_b16 v[54:55], v12 offset:33792
  v_mfma_f32_16x16x32_bf16 v[32:35], v[64:67], v[152:155], v[32:35]
  v_mfma_f32_16x16x32_bf16 v[28:31], v[64:67], v[116:119], v[28:31]
  v_mfma_f32_16x16x32_bf16 v[28:31], v[44:47], v[120:123], v[28:31]
  v_mfma_f32_16x16x32_bf16 v[32:35], v[44:47], v[156:159], v[32:35]
  s_waitcnt lgkmcnt(4)
  v_mfma_f32_16x16x32_bf16 v[32:35], v[48:51], v[160:163], v[32:35]
  v_mfma_f32_16x16x32_bf16 v[28:31], v[48:51], v[124:127], v[28:31]
  s_waitcnt lgkmcnt(0)
  s_barrier
  v_mfma_f32_16x16x32_bf16 v[28:31], v[52:55], v[128:131], v[28:31]
  ds_read_b64_tr_b16 v[56:57], v11 offset:0
  ds_read_b64_tr_b16 v[58:59], v11 offset:2048
  v_mfma_f32_16x16x32_bf16 v[32:35], v[52:55], v[164:167], v[32:35]
  ds_read_b64_tr_b16 v[60:61], v11 offset:4096
  ds_read_b64_tr_b16 v[62:63], v11 offset:6144
  s_waitcnt lgkmcnt(2)
  v_mfma_f32_16x16x32_bf16 v[36:39], v[56:59], v[96:99], 0
  ds_read_b64_tr_b16 v[64:65], v11 offset:8192
  ds_read_b64_tr_b16 v[66:67], v11 offset:10240
  v_mfma_f32_16x16x32_bf16 v[40:43], v[56:59], v[132:135], 0
  ds_read_b64_tr_b16 v[44:45], v11 offset:14336
  ds_read_b64_tr_b16 v[46:47], v11 offset:16384
  s_waitcnt lgkmcnt(4)
  v_mfma_f32_16x16x32_bf16 v[40:43], v[60:63], v[136:139], v[40:43]
  ds_read_b64_tr_b16 v[48:49], v11 offset:18432
  ds_read_b64_tr_b16 v[50:51], v11 offset:20480
  v_mfma_f32_16x16x32_bf16 v[36:39], v[60:63], v[100:103], v[36:39]
  ds_read_b64_tr_b16 v[52:53], v11 offset:22528
  ds_read_b64_tr_b16 v[54:55], v11 offset:24576
  s_waitcnt lgkmcnt(6)
  v_mfma_f32_16x16x32_bf16 v[36:39], v[64:67], v[104:107], v[36:39]
  ds_read_b64_tr_b16 v[56:57], v11 offset:12288
  ds_read_b64_tr_b16 v[58:59], v11 offset:26624
  v_mfma_f32_16x16x32_bf16 v[40:43], v[64:67], v[140:143], v[40:43]
  ds_read_b64_tr_b16 v[60:61], v12 offset:35840
  s_waitcnt lgkmcnt(7)
  v_mfma_f32_16x16x32_bf16 v[40:43], v[44:47], v[144:147], v[40:43]
  ds_read_b64_tr_b16 v[62:63], v13 offset:37376
  v_mfma_f32_16x16x32_bf16 v[36:39], v[44:47], v[108:111], v[36:39]
  ds_read_b64_tr_b16 v[64:65], v13 offset:39424
  v_cvt_pk_bf16_f32 v68, v28, v29
  v_cvt_pk_bf16_f32 v69, v30, v31
  v_cvt_pk_bf16_f32 v70, v32, v33
  v_cvt_pk_bf16_f32 v71, v34, v35
  v_readfirstlane_b32 s75, v7
  s_nop 0
  s_add_u32 s97, s97, s75
  s_add_u32 s3, s3, s75
  s_add_u32 s97, s97, 131072
  s_cmp_ge_u32 s97, s84
  s_cselect_b32 s75, 917504, 0
  s_sub_u32 s97, s97, s75
  buffer_store_dwordx4 v[68:71], v2, s[32:35], s97 offen sc1
  s_waitcnt lgkmcnt(7)
  v_mfma_f32_16x16x32_bf16 v[36:39], v[48:51], v[112:115], v[36:39]
  ds_read_b64_tr_b16 v[66:67], v12 offset:40960
  v_mfma_f32_16x16x32_bf16 v[40:43], v[48:51], v[148:151], v[40:43]
  s_waitcnt lgkmcnt(0)
  s_barrier
  v_mfma_f32_16x16x32_bf16 v[40:43], v[52:55], v[152:155], v[40:43]
  ds_read_b64_tr_b16 v[44:45], v10 offset:0
  ds_read_b64_tr_b16 v[46:47], v10 offset:2048
  v_mfma_f32_16x16x32_bf16 v[36:39], v[52:55], v[116:119], v[36:39]
  ds_read_b64_tr_b16 v[48:49], v10 offset:4096
  v_mfma_f32_16x16x32_bf16 v[36:39], v[56:59], v[120:123], v[36:39]
  ds_read_b64_tr_b16 v[50:51], v10 offset:6144
  v_mfma_f32_16x16x32_bf16 v[40:43], v[56:59], v[156:159], v[40:43]
  ds_read_b64_tr_b16 v[52:53], v10 offset:8192
  v_mfma_f32_16x16x32_bf16 v[40:43], v[60:63], v[160:163], v[40:43]
  ds_read_b64_tr_b16 v[54:55], v10 offset:10240
  v_mfma_f32_16x16x32_bf16 v[36:39], v[60:63], v[124:127], v[36:39]
  ds_read_b64_tr_b16 v[56:57], v10 offset:14336
  v_mfma_f32_16x16x32_bf16 v[36:39], v[64:67], v[128:131], v[36:39]
  ds_read_b64_tr_b16 v[58:59], v10 offset:16384
  v_mfma_f32_16x16x32_bf16 v[40:43], v[64:67], v[164:167], v[40:43]
  ds_read_b64_tr_b16 v[60:61], v10 offset:18432
  s_waitcnt lgkmcnt(7)
  v_mfma_f32_16x16x32_bf16 v[28:31], v[44:47], v[96:99], 0
  ds_read_b64_tr_b16 v[62:63], v10 offset:20480
  v_mfma_f32_16x16x32_bf16 v[32:35], v[44:47], v[132:135], 0
  ds_read_b64_tr_b16 v[64:65], v10 offset:22528
  s_waitcnt lgkmcnt(7)
  v_mfma_f32_16x16x32_bf16 v[32:35], v[48:51], v[136:139], v[32:35]
  ds_read_b64_tr_b16 v[66:67], v10 offset:24576
  v_mfma_f32_16x16x32_bf16 v[28:31], v[48:51], v[100:103], v[28:31]
  ds_read_b64_tr_b16 v[44:45], v10 offset:12288
  s_waitcnt lgkmcnt(7)
  v_mfma_f32_16x16x32_bf16 v[28:31], v[52:55], v[104:107], v[28:31]
  ds_read_b64_tr_b16 v[46:47], v10 offset:26624
  v_mfma_f32_16x16x32_bf16 v[32:35], v[52:55], v[140:143], v[32:35]
  ds_read_b64_tr_b16 v[48:49], v12 offset:43008
  s_waitcnt lgkmcnt(7)
  v_mfma_f32_16x16x32_bf16 v[32:35], v[56:59], v[144:147], v[32:35]
  ds_read_b64_tr_b16 v[50:51], v13 offset:44544
  v_mfma_f32_16x16x32_bf16 v[28:31], v[56:59], v[108:111], v[28:31]
  ds_read_b64_tr_b16 v[52:53], v13 offset:46592
  v_cvt_pk_bf16_f32 v72, v36, v37
  v_cvt_pk_bf16_f32 v73, v38, v39
  v_cvt_pk_bf16_f32 v74, v40, v41
  v_cvt_pk_bf16_f32 v75, v42, v43
  s_add_u32 s97, s97, 131072
  s_cmp_ge_u32 s97, s84
  s_cselect_b32 s75, 917504, 0
  s_sub_u32 s97, s97, s75
  buffer_store_dwordx4 v[72:75], v2, s[32:35], s97 offen sc1
  s_waitcnt lgkmcnt(7)
  v_mfma_f32_16x16x32_bf16 v[28:31], v[60:63], v[112:115], v[28:31]
  ds_read_b64_tr_b16 v[54:55], v12 offset:48128
  v_mfma_f32_16x16x32_bf16 v[32:35], v[60:63], v[148:151], v[32:35]
  s_waitcnt lgkmcnt(0)
  s_barrier
  v_mfma_f32_16x16x32_bf16 v[32:35], v[64:67], v[152:155], v[32:35]
  ds_read_b64_tr_b16 v[56:57], v10 offset:28672
  ds_read_b64_tr_b16 v[58:59], v10 offset:30720
  v_mfma_f32_16x16x32_bf16 v[28:31], v[64:67], v[116:119], v[28:31]
  ds_read_b64_tr_b16 v[60:61], v10 offset:32768
  v_mfma_f32_16x16x32_bf16 v[28:31], v[44:47], v[120:123], v[28:31]
  ds_read_b64_tr_b16 v[62:63], v10 offset:34816
  v_mfma_f32_16x16x32_bf16 v[32:35], v[44:47], v[156:159], v[32:35]
  ds_read_b64_tr_b16 v[64:65], v10 offset:36864
  v_mfma_f32_16x16x32_bf16 v[32:35], v[48:51], v[160:163], v[32:35]
  ds_read_b64_tr_b16 v[66:67], v10 offset:38912
  v_mfma_f32_16x16x32_bf16 v[28:31], v[48:51], v[124:127], v[28:31]
  ds_read_b64_tr_b16 v[44:45], v10 offset:43008
  v_mfma_f32_16x16x32_bf16 v[28:31], v[52:55], v[128:131], v[28:31]
  ds_read_b64_tr_b16 v[46:47], v10 offset:45056
  v_mfma_f32_16x16x32_bf16 v[32:35], v[52:55], v[164:167], v[32:35]
  ds_read_b64_tr_b16 v[48:49], v10 offset:47104
  s_waitcnt lgkmcnt(7)
  v_mfma_f32_16x16x32_bf16 v[36:39], v[56:59], v[96:99], 0
  ds_read_b64_tr_b16 v[50:51], v10 offset:49152
  v_mfma_f32_16x16x32_bf16 v[40:43], v[56:59], v[132:135], 0
  ds_read_b64_tr_b16 v[52:53], v10 offset:51200
  s_waitcnt lgkmcnt(7)
  v_mfma_f32_16x16x32_bf16 v[40:43], v[60:63], v[136:139], v[40:43]
  ds_read_b64_tr_b16 v[54:55], v10 offset:53248
  v_mfma_f32_16x16x32_bf16 v[36:39], v[60:63], v[100:103], v[36:39]
  ds_read_b64_tr_b16 v[56:57], v10 offset:40960
  s_waitcnt lgkmcnt(7)
  v_mfma_f32_16x16x32_bf16 v[36:39], v[64:67], v[104:107], v[36:39]
  ds_read_b64_tr_b16 v[58:59], v10 offset:55296
  v_mfma_f32_16x16x32_bf16 v[40:43], v[64:67], v[140:143], v[40:43]
  ds_read_b64_tr_b16 v[60:61], v12 offset:50176
  s_waitcnt lgkmcnt(7)
  v_mfma_f32_16x16x32_bf16 v[40:43], v[44:47], v[144:147], v[40:43]
  ds_read_b64_tr_b16 v[62:63], v13 offset:51712
  v_mfma_f32_16x16x32_bf16 v[36:39], v[44:47], v[108:111], v[36:39]
  ds_read_b64_tr_b16 v[64:65], v13 offset:53760
  v_cvt_pk_bf16_f32 v76, v28, v29
  v_cvt_pk_bf16_f32 v77, v30, v31
  v_cvt_pk_bf16_f32 v78, v32, v33
  v_cvt_pk_bf16_f32 v79, v34, v35
  s_add_u32 s97, s97, 131072
  s_cmp_ge_u32 s97, s84
  s_cselect_b32 s75, 917504, 0
  s_sub_u32 s97, s97, s75
  buffer_store_dwordx4 v[76:79], v2, s[32:35], s97 offen sc1
  s_waitcnt lgkmcnt(7)
  v_mfma_f32_16x16x32_bf16 v[36:39], v[48:51], v[112:115], v[36:39]
  ds_read_b64_tr_b16 v[66:67], v12 offset:55296
  v_mfma_f32_16x16x32_bf16 v[40:43], v[48:51], v[148:151], v[40:43]
  s_waitcnt vmcnt(2) lgkmcnt(0)
  s_barrier
  v_mfma_f32_16x16x32_bf16 v[40:43], v[52:55], v[152:155], v[40:43]
  ds_read_b64_tr_b16 v[44:45], v12 offset:0
  ds_read_b64_tr_b16 v[46:47], v12 offset:2048
  v_mfma_f32_16x16x32_bf16 v[36:39], v[52:55], v[116:119], v[36:39]
  ds_read_b64_tr_b16 v[48:49], v12 offset:4096
  v_mfma_f32_16x16x32_bf16 v[36:39], v[56:59], v[120:123], v[36:39]
  ds_read_b64_tr_b16 v[50:51], v12 offset:6144
  v_mfma_f32_16x16x32_bf16 v[40:43], v[56:59], v[156:159], v[40:43]
  ds_read_b64_tr_b16 v[52:53], v12 offset:8192
  v_mfma_f32_16x16x32_bf16 v[40:43], v[60:63], v[160:163], v[40:43]
  ds_read_b64_tr_b16 v[54:55], v12 offset:10240
  v_mfma_f32_16x16x32_bf16 v[36:39], v[60:63], v[124:127], v[36:39]
  ds_read_b64_tr_b16 v[56:57], v12 offset:14336
  v_mfma_f32_16x16x32_bf16 v[36:39], v[64:67], v[128:131], v[36:39]
  ds_read_b64_tr_b16 v[58:59], v12 offset:16384
  v_mfma_f32_16x16x32_bf16 v[40:43], v[64:67], v[164:167], v[40:43]
  ds_read_b64_tr_b16 v[60:61], v12 offset:18432
  s_waitcnt lgkmcnt(7)
  v_mfma_f32_16x16x32_bf16 v[28:31], v[44:47], v[96:99], 0
  ds_read_b64_tr_b16 v[62:63], v12 offset:20480
  v_mfma_f32_16x16x32_bf16 v[32:35], v[44:47], v[132:135], 0
  ds_read_b64_tr_b16 v[64:65], v12 offset:22528
  s_waitcnt lgkmcnt(7)
  v_mfma_f32_16x16x32_bf16 v[32:35], v[48:51], v[136:139], v[32:35]
  ds_read_b64_tr_b16 v[66:67], v12 offset:24576
  v_mfma_f32_16x16x32_bf16 v[28:31], v[48:51], v[100:103], v[28:31]
  ds_read_b64_tr_b16 v[44:45], v12 offset:12288
  s_waitcnt lgkmcnt(7)
  v_mfma_f32_16x16x32_bf16 v[28:31], v[52:55], v[104:107], v[28:31]
  ds_read_b64_tr_b16 v[46:47], v12 offset:26624
  v_mfma_f32_16x16x32_bf16 v[32:35], v[52:55], v[140:143], v[32:35]
  ds_read_b64_tr_b16 v[48:49], v12 offset:28672
  s_waitcnt lgkmcnt(7)
  v_mfma_f32_16x16x32_bf16 v[32:35], v[56:59], v[144:147], v[32:35]
  ds_read_b64_tr_b16 v[50:51], v13 offset:30208
  v_mfma_f32_16x16x32_bf16 v[28:31], v[56:59], v[108:111], v[28:31]
  ds_read_b64_tr_b16 v[52:53], v13 offset:32256
  v_cvt_pk_bf16_f32 v80, v36, v37
  v_cvt_pk_bf16_f32 v81, v38, v39
  v_cvt_pk_bf16_f32 v82, v40, v41
  v_cvt_pk_bf16_f32 v83, v42, v43
  s_add_u32 s97, s97, 131072
  s_cmp_ge_u32 s97, s84
  s_cselect_b32 s75, 917504, 0
  s_sub_u32 s97, s97, s75
  buffer_store_dwordx4 v[80:83], v2, s[32:35], s97 offen sc1
  s_waitcnt lgkmcnt(7)
  v_mfma_f32_16x16x32_bf16 v[28:31], v[60:63], v[112:115], v[28:31]
  ds_read_b64_tr_b16 v[54:55], v12 offset:33792
  v_mfma_f32_16x16x32_bf16 v[32:35], v[60:63], v[148:151], v[32:35]
  s_waitcnt vmcnt(1) lgkmcnt(0)
  s_barrier
  v_mfma_f32_16x16x32_bf16 v[32:35], v[64:67], v[152:155], v[32:35]
  ds_read_b64_tr_b16 v[56:57], v11 offset:0
  ds_read_b64_tr_b16 v[58:59], v11 offset:2048
  v_mfma_f32_16x16x32_bf16 v[28:31], v[64:67], v[116:119], v[28:31]
  ds_read_b64_tr_b16 v[60:61], v11 offset:4096
  v_mfma_f32_16x16x32_bf16 v[28:31], v[44:47], v[120:123], v[28:31]
  ds_read_b64_tr_b16 v[62:63], v11 offset:6144
  v_mfma_f32_16x16x32_bf16 v[32:35], v[44:47], v[156:159], v[32:35]
  ds_read_b64_tr_b16 v[64:65], v11 offset:8192
  v_mfma_f32_16x16x32_bf16 v[32:35], v[48:51], v[160:163], v[32:35]
  ds_read_b64_tr_b16 v[66:67], v11 offset:10240
  v_mfma_f32_16x16x32_bf16 v[28:31], v[48:51], v[124:127], v[28:31]
  ds_read_b64_tr_b16 v[44:45], v11 offset:14336
  v_mfma_f32_16x16x32_bf16 v[28:31], v[52:55], v[128:131], v[28:31]
  ds_read_b64_tr_b16 v[46:47], v11 offset:16384
  v_mfma_f32_16x16x32_bf16 v[32:35], v[52:55], v[164:167], v[32:35]
  ds_read_b64_tr_b16 v[48:49], v11 offset:18432
  s_waitcnt lgkmcnt(7)
  v_mfma_f32_16x16x32_bf16 v[36:39], v[56:59], v[96:99], 0
  ds_read_b64_tr_b16 v[50:51], v11 offset:20480
  v_mfma_f32_16x16x32_bf16 v[40:43], v[56:59], v[132:135], 0
  ds_read_b64_tr_b16 v[52:53], v11 offset:22528
  s_waitcnt lgkmcnt(7)
  v_mfma_f32_16x16x32_bf16 v[40:43], v[60:63], v[136:139], v[40:43]
  ds_read_b64_tr_b16 v[54:55], v11 offset:24576
  v_mfma_f32_16x16x32_bf16 v[36:39], v[60:63], v[100:103], v[36:39]
  ds_read_b64_tr_b16 v[56:57], v11 offset:12288
  s_waitcnt lgkmcnt(7)
  v_mfma_f32_16x16x32_bf16 v[36:39], v[64:67], v[104:107], v[36:39]
  ds_read_b64_tr_b16 v[58:59], v11 offset:26624
  v_mfma_f32_16x16x32_bf16 v[40:43], v[64:67], v[140:143], v[40:43]
  ds_read_b64_tr_b16 v[60:61], v12 offset:57344
  s_waitcnt lgkmcnt(7)
  v_mfma_f32_16x16x32_bf16 v[40:43], v[44:47], v[144:147], v[40:43]
  ds_read_b64_tr_b16 v[62:63], v13 offset:58880
  v_mfma_f32_16x16x32_bf16 v[36:39], v[44:47], v[108:111], v[36:39]
  ds_read_b64_tr_b16 v[64:65], v13 offset:60928
  v_cvt_pk_bf16_f32 v84, v28, v29
  v_cvt_pk_bf16_f32 v85, v30, v31
  v_cvt_pk_bf16_f32 v86, v32, v33
  v_cvt_pk_bf16_f32 v87, v34, v35
  s_add_u32 s97, s97, 131072
  s_cmp_ge_u32 s97, s84
  s_cselect_b32 s75, 917504, 0
  s_sub_u32 s97, s97, s75
  buffer_store_dwordx4 v[84:87], v2, s[32:35], s97 offen sc1
  s_waitcnt lgkmcnt(7)
  v_mfma_f32_16x16x32_bf16 v[36:39], v[48:51], v[112:115], v[36:39]
  ds_read_b64_tr_b16 v[66:67], v12 offset:62464
  v_mfma_f32_16x16x32_bf16 v[40:43], v[48:51], v[148:151], v[40:43]
  s_waitcnt lgkmcnt(6)
  v_mfma_f32_16x16x32_bf16 v[40:43], v[52:55], v[152:155], v[40:43]
  v_mfma_f32_16x16x32_bf16 v[36:39], v[52:55], v[116:119], v[36:39]
  s_waitcnt lgkmcnt(4)
  v_mfma_f32_16x16x32_bf16 v[36:39], v[56:59], v[120:123], v[36:39]
  v_mfma_f32_16x16x32_bf16 v[40:43], v[56:59], v[156:159], v[40:43]
  s_waitcnt lgkmcnt(2)
  v_mfma_f32_16x16x32_bf16 v[40:43], v[60:63], v[160:163], v[40:43]
  v_mfma_f32_16x16x32_bf16 v[36:39], v[60:63], v[124:127], v[36:39]
  s_waitcnt lgkmcnt(0)
  v_mfma_f32_16x16x32_bf16 v[36:39], v[64:67], v[128:131], v[36:39]
  v_mfma_f32_16x16x32_bf16 v[40:43], v[64:67], v[164:167], v[40:43]
  v_and_b32 v4, 15, v1
  v_bfe_u32 v5, v1, 1, 2
  s_lshr_b32 s76, s93, 1
  v_xor_b32 v5, s76, v5
  v_lshlrev_b32 v5, 5, v5
  v_lshl_add_u32 v5, v4, 7, v5
  v_lshrrev_b32 v6, 4, v1
  v_lshlrev_b32 v6, 3, v6
  v_cvt_pk_bf16_f32 v88, v36, v37
  v_cvt_pk_bf16_f32 v89, v38, v39
  v_cvt_pk_bf16_f32 v90, v40, v41
  v_cvt_pk_bf16_f32 v91, v42, v43
  s_add_u32 s97, s97, 131072
  s_cmp_ge_u32 s97, s84
  s_cselect_b32 s75, 917504, 0
  s_sub_u32 s97, s97, s75
  buffer_store_dwordx4 v[88:91], v2, s[32:35], s97 offen sc1
  s_cmp_eq_u32 s65, 7
  s_cbranch_scc1 L_s72
  s_lshl_b32 s83, s65, 7
  s_lshl_b32 s75, s72, 12
  s_add_u32 s75, s75, 153600
  v_add3_u32 v5, v5, v6, s75
  s_lshl_b32 s76, s76, 5
  s_add_u32 s83, s83, s76
  s_movk_i32 s55, 0x3f80
  s_add_u32 s76, s76, 161792
  v_add_u32 v6, s76, v6
  ds_read_b64 v[14:15], v5
  ds_read_b64 v[16:17], v5 offset:2048
  ds_read_b64 v[18:19], v6
  s_lshl_b32 s75, s72, 6
  s_add_u32 s75, s75, s74
  v_lshl_add_u32 v4, v4, 1, s75
  v_bfe_u32 v5, v1, 4, 1
  v_lshl_add_u32 v4, v5, 5, v4
  v_mul_u32_u24 v4, 896, v4
  v_lshrrev_b32 v6, 5, v1
  v_lshl_add_u32 v8, v6, 4, v4
  v_mov_b32 v9, 0x3f800000
  s_waitcnt lgkmcnt(0)
  v_lshlrev_b32 v4, 16, v18
  v_and_b32 v5, 0xffff0000, v18
  v_dot2_f32_bf16 v28, v14, s55, v4
  v_dot2_f32_bf16 v29, v14, v9, v5
  v_dot2_f32_bf16 v32, v16, s55, v4
  v_dot2_f32_bf16 v33, v16, v9, v5
  v_lshlrev_b32 v4, 16, v19
  v_and_b32 v5, 0xffff0000, v19
  v_dot2_f32_bf16 v30, v15, s55, v4
  v_dot2_f32_bf16 v31, v15, v9, v5
  v_dot2_f32_bf16 v34, v17, s55, v4
  v_dot2_f32_bf16 v35, v17, v9, v5
  v_mov_b32 v4, 161920
  v_mov_b32 v5, 1
  s_add_u32 s11, s65, 4
  s_sub_u32 s10, s11, 7
  s_min_u32 s11, s11, s10
  s_lshl_b32 s11, s11, 10
  s_add_u32 s11, s11, s3
  s_cmp_eq_u32 s65, 7
  s_cselect_b32 s10, 64, 8
  s_add_u32 s13, s65, 5
  s_sub_u32 s12, s13, 7
  s_min_u32 s13, s13, s12
  s_lshl_b32 s13, s13, 10
  s_add_u32 s13, s13, s3
  s_cmp_eq_u32 s65, 7
  s_cselect_b32 s12, 64, 16
  s_add_u32 s15, s65, 6
  s_sub_u32 s14, s15, 7
  s_min_u32 s15, s15, s14
  s_lshl_b32 s15, s15, 10
  s_add_u32 s15, s15, s3
  s_cmp_eq_u32 s65, 7
  s_cselect_b32 s14, 64, 32
  s_mov_b64 exec, 1
  s_waitcnt vmcnt(0)
  ds_add_rtn_u32 v5, v4, v5
  s_waitcnt lgkmcnt(0)
  v_cmp_eq_u32 vcc, 7, v5
  s_mov_b64 exec, -1
  s_nop 0
  s_cbranch_vccz L_nf3
  s_atomic_add s14, s[32:33], s15
  s_atomic_add s12, s[32:33], s13
  s_atomic_add s10, s[32:33], s11
L_nf3:
L_ns1:
  v_mov_b32 v6, 161932
  s_mov_b32 s96, 0
L_lw4:
  ds_read_b32 v7, v6
  s_add_u32 s96, s96, 1
  s_cmp_gt_u32 s96, 3200000
  s_waitcnt lgkmcnt(0)
  v_cmp_gt_u32 vcc, 2, v7
  s_cbranch_scc1 L_lo5
  s_nop 0
  s_cbranch_vccnz L_lw4
L_lo5:
  ds_read_b64_tr_b16 v[44:45], v10 offset:0
  ds_read_b64_tr_b16 v[46:47], v10 offset:2048
  ds_read_b64_tr_b16 v[48:49], v10 offset:4096
  ds_read_b64_tr_b16 v[50:51], v10 offset:6144
  ds_read_b64_tr_b16 v[52:53], v10 offset:8192
  ds_read_b64_tr_b16 v[54:55], v10 offset:10240
  ds_read_b64_tr_b16 v[56:57], v10 offset:14336
  ds_read_b64_tr_b16 v[58:59], v10 offset:16384
  ds_read_b64_tr_b16 v[60:61], v10 offset:18432
  ds_read_b64_tr_b16 v[62:63], v10 offset:20480
  ds_read_b64_tr_b16 v[64:65], v10 offset:22528
  ds_read_b64_tr_b16 v[66:67], v10 offset:24576
  s_waitcnt lgkmcnt(10)
  v_mfma_f32_16x16x32_bf16 v[28:31], v[44:47], v[96:99], v[28:31]
  v_mfma_f32_16x16x32_bf16 v[32:35], v[44:47], v[132:135], v[32:35]
  ds_read_b64_tr_b16 v[44:45], v10 offset:12288
  ds_read_b64_tr_b16 v[46:47], v10 offset:26624
  s_waitcnt lgkmcnt(10)
  v_mfma_f32_16x16x32_bf16 v[32:35], v[48:51], v[136:139], v[32:35]
  v_mfma_f32_16x16x32_bf16 v[28:31], v[48:51], v[100:103], v[28:31]
  ds_read_b64_tr_b16 v[48:49], v12 offset:35840
  ds_read_b64_tr_b16 v[50:51], v13 offset:37376
  s_waitcnt lgkmcnt(10)
  v_mfma_f32_16x16x32_bf16 v[28:31], v[52:55], v[104:107], v[28:31]
  v_mfma_f32_16x16x32_bf16 v[32:35], v[52:55], v[140:143], v[32:35]
  ds_read_b64_tr_b16 v[52:53], v13 offset:39424
  ds_read_b64_tr_b16 v[54:55], v12 offset:40960
  s_waitcnt lgkmcnt(10)
  v_mfma_f32_16x16x32_bf16 v[32:35], v[56:59], v[144:147], v[32:35]
  v_mfma_f32_16x16x32_bf16 v[28:31], v[56:59], v[108:111], v[28:31]
  s_waitcnt lgkmcnt(8)
  v_mfma_f32_16x16x32_bf16 v[28:31], v[60:63], v[112:115], v[28:31]
  v_mfma_f32_16x16x32_bf16 v[32:35], v[60:63], v[148:151], v[32:35]
  s_waitcnt lgkmcnt(6)
  v_mfma_f32_16x16x32_bf16 v[32:35], v[64:67], v[152:155], v[32:35]
  v_mfma_f32_16x16x32_bf16 v[28:31], v[64:67], v[116:119], v[28:31]
  s_waitcnt lgkmcnt(4)
  v_mfma_f32_16x16x32_bf16 v[28:31], v[44:47], v[120:123], v[28:31]
  v_mfma_f32_16x16x32_bf16 v[32:35], v[44:47], v[156:159], v[32:35]
  s_waitcnt lgkmcnt(2)
  v_mfma_f32_16x16x32_bf16 v[32:35], v[48:51], v[160:163], v[32:35]
  v_mfma_f32_16x16x32_bf16 v[28:31], v[48:51], v[124:127], v[28:31]
  s_waitcnt lgkmcnt(0)
  v_mfma_f32_16x16x32_bf16 v[28:31], v[52:55], v[128:131], v[28:31]
  v_mfma_f32_16x16x32_bf16 v[32:35], v[52:55], v[164:167], v[32:35]
  s_cmp_lg_u32 s65, 7
  s_cbranch_scc1 L_own6
  s_nop 5
  v_cvt_pk_bf16_f32 v92, v28, v29
  v_cvt_pk_bf16_f32 v93, v30, v31
  v_cvt_pk_bf16_f32 v94, v32, v33
  v_cvt_pk_bf16_f32 v95, v34, v35
  s_add_u32 s97, s97, 131072
  s_cmp_ge_u32 s97, s84
  s_cselect_b32 s75, 917504, 0
  s_sub_u32 s97, s97, s75
  buffer_store_dwordx4 v[92:95], v2, s[32:35], s97 offen sc1
  v_mov_b32 v4, 161928
  v_mov_b32 v5, 1
  s_add_u32 s11, s65, 4
  s_sub_u32 s10, s11, 7
  s_min_u32 s11, s11, s10
  s_lshl_b32 s11, s11, 10
  s_add_u32 s11, s11, s3
  s_cmp_eq_u32 s65, 7
  s_cselect_b32 s10, 64, 8
  s_add_u32 s13, s65, 5
  s_sub_u32 s12, s13, 7
  s_min_u32 s13, s13, s12
  s_lshl_b32 s13, s13, 10
  s_add_u32 s13, s13, s3
  s_cmp_eq_u32 s65, 7
  s_cselect_b32 s12, 64, 16
  s_add_u32 s15, s65, 6
  s_sub_u32 s14, s15, 7
  s_min_u32 s15, s15, s14
  s_lshl_b32 s15, s15, 10
  s_add_u32 s15, s15, s3
  s_cmp_eq_u32 s65, 7
  s_cselect_b32 s14, 64, 32
  s_mov_b64 exec, 1
  s_waitcnt vmcnt(1)
  ds_add_rtn_u32 v5, v4, v5
  s_waitcnt lgkmcnt(0)
  v_cmp_eq_u32 vcc, 7, v5
  s_mov_b64 exec, -1
  s_nop 0
  s_cbranch_vccz L_nf8
  s_atomic_add s14, s[32:33], s15
  s_atomic_add s12, s[32:33], s13
  s_atomic_add s10, s[32:33], s11
L_nf8:
  v_mov_b32 v4, 161920
  v_mov_b32 v5, 1
  s_add_u32 s17, s65, 0
  s_sub_u32 s16, s17, 7
  s_min_u32 s17, s17, s16
  s_lshl_b32 s17, s17, 10
  s_add_u32 s17, s17, s3
  s_cmp_eq_u32 s65, 7
  s_cselect_b32 s16, 64, 64
  s_mov_b64 exec, 1
  s_waitcnt vmcnt(0)
  ds_add_rtn_u32 v5, v4, v5
  s_waitcnt lgkmcnt(0)
  v_cmp_eq_u32 vcc, 7, v5
  s_mov_b64 exec, -1
  s_nop 0
  s_cbranch_vccz L_nf9
  s_atomic_add s16, s[32:33], s17
L_nf9:
  s_branch L_done7
L_own6:
  s_nop 0
  v_add_u32 v4, s81, v2
  v_add_u32 v5, 65536, v4
  s_nop 1
  v_mov_b32 v6, 161936
  s_mov_b32 s96, 0
L_lw10:
  ds_read_b32 v7, v6
  s_add_u32 s96, s96, 1
  s_cmp_gt_u32 s96, 3200000
  s_waitcnt lgkmcnt(0)
  v_cmp_gt_u32 vcc, 1, v7
  s_cbranch_scc1 L_lo11
  s_nop 0
  s_cbranch_vccnz L_lw10
L_lo11:
  ds_read_b128 v[68:71], v5 offset:28672
  ds_read_b128 v[72:75], v5 offset:36864
  ds_read_b128 v[76:79], v5 offset:45056
  s_waitcnt lgkmcnt(2)
  v_dot2_f32_bf16 v28, v68, s55, v28
  v_dot2_f32_bf16 v29, v68, v9, v29
  v_dot2_f32_bf16 v30, v69, s55, v30
  v_dot2_f32_bf16 v31, v69, v9, v31
  v_dot2_f32_bf16 v32, v70, s55, v32
  v_dot2_f32_bf16 v33, v70, v9, v33
  v_dot2_f32_bf16 v34, v71, s55, v34
  v_dot2_f32_bf16 v35, v71, v9, v35
  s_waitcnt lgkmcnt(1)
  v_dot2_f32_bf16 v28, v72, s55, v28
  v_dot2_f32_bf16 v29, v72, v9, v29
  v_dot2_f32_bf16 v30, v73, s55, v30
  v_dot2_f32_bf16 v31, v73, v9, v31
  v_dot2_f32_bf16 v32, v74, s55, v32
  v_dot2_f32_bf16 v33, v74, v9, v33
  v_dot2_f32_bf16 v34, v75, s55, v34
  v_dot2_f32_bf16 v35, v75, v9, v35
  s_waitcnt lgkmcnt(0)
  v_dot2_f32_bf16 v28, v76, s55, v28
  v_dot2_f32_bf16 v29, v76, v9, v29
  v_dot2_f32_bf16 v30, v77, s55, v30
  v_dot2_f32_bf16 v31, v77, v9, v31
  v_dot2_f32_bf16 v32, v78, s55, v32
  v_dot2_f32_bf16 v33, v78, v9, v33
  v_dot2_f32_bf16 v34, v79, s55, v34
  v_dot2_f32_bf16 v35, v79, v9, v35
  s_barrier
  ds_read_b128 v[80:83], v4 offset:0
  ds_read_b128 v[84:87], v4 offset:8192
  ds_read_b128 v[88:91], v4 offset:16384
  ds_read_b128 v[92:95], v4 offset:24576
  s_waitcnt lgkmcnt(3)
  v_dot2_f32_bf16 v28, v80, s55, v28
  v_dot2_f32_bf16 v29, v80, v9, v29
  v_dot2_f32_bf16 v30, v81, s55, v30
  v_dot2_f32_bf16 v31, v81, v9, v31
  v_dot2_f32_bf16 v32, v82, s55, v32
  v_dot2_f32_bf16 v33, v82, v9, v33
  v_dot2_f32_bf16 v34, v83, s55, v34
  v_dot2_f32_bf16 v35, v83, v9, v35
  s_waitcnt lgkmcnt(2)
  v_dot2_f32_bf16 v28, v84, s55, v28
  v_dot2_f32_bf16 v29, v84, v9, v29
  v_dot2_f32_bf16 v30, v85, s55, v30
  v_dot2_f32_bf16 v31, v85, v9, v31
  v_dot2_f32_bf16 v32, v86, s55, v32
  v_dot2_f32_bf16 v33, v86, v9, v33
  v_dot2_f32_bf16 v34, v87, s55, v34
  v_dot2_f32_bf16 v35, v87, v9, v35
  s_waitcnt lgkmcnt(1)
  v_dot2_f32_bf16 v28, v88, s55, v28
  v_dot2_f32_bf16 v29, v88, v9, v29
  v_dot2_f32_bf16 v30, v89, s55, v30
  v_dot2_f32_bf16 v31, v89, v9, v31
  v_dot2_f32_bf16 v32, v90, s55, v32
  v_dot2_f32_bf16 v33, v90, v9, v33
  v_dot2_f32_bf16 v34, v91, s55, v34
  v_dot2_f32_bf16 v35, v91, v9, v35
  s_waitcnt lgkmcnt(0)
  v_dot2_f32_bf16 v28, v92, s55, v28
  v_dot2_f32_bf16 v29, v92, v9, v29
  v_dot2_f32_bf16 v30, v93, s55, v30
  v_dot2_f32_bf16 v31, v93, v9, v31
  v_dot2_f32_bf16 v32, v94, s55, v32
  v_dot2_f32_bf16 v33, v94, v9, v33
  v_dot2_f32_bf16 v34, v95, s55, v34
  v_dot2_f32_bf16 v35, v95, v9, v35
  s_nop 1
  v_cvt_pk_bf16_f32 v20, v28, v29
  v_cvt_pk_bf16_f32 v21, v30, v31
  v_cvt_pk_bf16_f32 v22, v32, v33
  v_cvt_pk_bf16_f32 v23, v34, v35
  s_nop 1
  v_permlane16_swap_b32 v20, v22
  v_permlane16_swap_b32 v21, v23
  s_nop 0
  buffer_store_dwordx4 v[20:23], v8, s[36:39], s83 offen
L_done7:
  s_endpgm
L_A2:
  s_waitcnt vmcnt(6)
  v_lshlrev_b32 v80, 16, v136
  v_and_b32 v81, 0xffff0000, v136
  v_pk_mul_f32 v[6:7], v[80:81], v[80:81]
  v_lshlrev_b32 v82, 16, v137
  v_and_b32 v83, 0xffff0000, v137
  v_pk_add_f32 v[4:5], v[80:81], v[82:83]
  v_pk_fma_f32 v[6:7], v[82:83], v[82:83], v[6:7]
  v_lshlrev_b32 v84, 16, v138
  v_and_b32 v85, 0xffff0000, v138
  v_pk_add_f32 v[4:5], v[4:5], v[84:85]
  v_pk_fma_f32 v[6:7], v[84:85], v[84:85], v[6:7]
  v_lshlrev_b32 v86, 16, v139
  v_and_b32 v87, 0xffff0000, v139
  v_pk_add_f32 v[4:5], v[4:5], v[86:87]
  v_pk_fma_f32 v[6:7], v[86:87], v[86:87], v[6:7]
  s_waitcnt vmcnt(5)
  v_lshlrev_b32 v88, 16, v140
  v_and_b32 v89, 0xffff0000, v140
  v_pk_add_f32 v[4:5], v[4:5], v[88:89]
  v_pk_fma_f32 v[6:7], v[88:89], v[88:89], v[6:7]
  v_lshlrev_b32 v90, 16, v141
  v_and_b32 v91, 0xffff0000, v141
  v_pk_add_f32 v[4:5], v[4:5], v[90:91]
  v_pk_fma_f32 v[6:7], v[90:91], v[90:91], v[6:7]
  v_lshlrev_b32 v92, 16, v142
  v_and_b32 v93, 0xffff0000, v142
  v_pk_add_f32 v[4:5], v[4:5], v[92:93]
  v_pk_fma_f32 v[6:7], v[92:93], v[92:93], v[6:7]
  v_lshlrev_b32 v94, 16, v143
  v_and_b32 v95, 0xffff0000, v143
  v_pk_add_f32 v[4:5], v[4:5], v[94:95]
  v_pk_fma_f32 v[6:7], v[94:95], v[94:95], v[6:7]
  s_waitcnt vmcnt(4)
  v_lshlrev_b32 v96, 16, v144
  v_and_b32 v97, 0xffff0000, v144
  v_pk_add_f32 v[4:5], v[4:5], v[96:97]
  v_pk_fma_f32 v[6:7], v[96:97], v[96:97], v[6:7]
  v_lshlrev_b32 v98, 16, v145
  v_and_b32 v99, 0xffff0000, v145
  v_pk_add_f32 v[4:5], v[4:5], v[98:99]
  v_pk_fma_f32 v[6:7], v[98:99], v[98:99], v[6:7]
  v_lshlrev_b32 v100, 16, v146
  v_and_b32 v101, 0xffff0000, v146
  v_pk_add_f32 v[4:5], v[4:5], v[100:101]
  v_pk_fma_f32 v[6:7], v[100:101], v[100:101], v[6:7]
  v_lshlrev_b32 v102, 16, v147
  v_and_b32 v103, 0xffff0000, v147
  v_pk_add_f32 v[4:5], v[4:5], v[102:103]
  v_pk_fma_f32 v[6:7], v[102:103], v[102:103], v[6:7]
  s_waitcnt vmcnt(3)
  v_lshlrev_b32 v104, 16, v148
  v_and_b32 v105, 0xffff0000, v148
  v_pk_add_f32 v[4:5], v[4:5], v[104:105]
  v_pk_fma_f32 v[6:7], v[104:105], v[104:105], v[6:7]
  v_lshlrev_b32 v106, 16, v149
  v_and_b32 v107, 0xffff0000, v149
  v_pk_add_f32 v[4:5], v[4:5], v[106:107]
  v_pk_fma_f32 v[6:7], v[106:107], v[106:107], v[6:7]
  v_lshlrev_b32 v108, 16, v150
  v_and_b32 v109, 0xffff0000, v150
  v_pk_add_f32 v[4:5], v[4:5], v[108:109]
  v_pk_fma_f32 v[6:7], v[108:109], v[108:109], v[6:7]
  v_lshlrev_b32 v110, 16, v151
  v_and_b32 v111, 0xffff0000, v151
  v_pk_add_f32 v[4:5], v[4:5], v[110:111]
  v_pk_fma_f32 v[6:7], v[110:111], v[110:111], v[6:7]
  s_waitcnt vmcnt(2)
  v_lshlrev_b32 v112, 16, v152
  v_and_b32 v113, 0xffff0000, v152
  v_pk_add_f32 v[4:5], v[4:5], v[112:113]
  v_pk_fma_f32 v[6:7], v[112:113], v[112:113], v[6:7]
  v_lshlrev_b32 v114, 16, v153
  v_and_b32 v115, 0xffff0000, v153
  v_pk_add_f32 v[4:5], v[4:5], v[114:115]
  v_pk_fma_f32 v[6:7], v[114:115], v[114:115], v[6:7]
  v_lshlrev_b32 v116, 16, v154
  v_and_b32 v117, 0xffff0000, v154
  v_pk_add_f32 v[4:5], v[4:5], v[116:117]
  v_pk_fma_f32 v[6:7], v[116:117], v[116:117], v[6:7]
  v_lshlrev_b32 v118, 16, v155
  v_and_b32 v119, 0xffff0000, v155
  v_pk_add_f32 v[4:5], v[4:5], v[118:119]
  v_pk_fma_f32 v[6:7], v[118:119], v[118:119], v[6:7]
  s_waitcnt vmcnt(1)
  v_lshlrev_b32 v120, 16, v156
  v_and_b32 v121, 0xffff0000, v156
  v_pk_add_f32 v[4:5], v[4:5], v[120:121]
  v_pk_fma_f32 v[6:7], v[120:121], v[120:121], v[6:7]
  v_lshlrev_b32 v122, 16, v157
  v_and_b32 v123, 0xffff0000, v157
  v_pk_add_f32 v[4:5], v[4:5], v[122:123]
  v_pk_fma_f32 v[6:7], v[122:123], v[122:123], v[6:7]
  v_lshlrev_b32 v124, 16, v158
  v_and_b32 v125, 0xffff0000, v158
  v_pk_add_f32 v[4:5], v[4:5], v[124:125]
  v_pk_fma_f32 v[6:7], v[124:125], v[124:125], v[6:7]
  v_lshlrev_b32 v126, 16, v159
  v_and_b32 v127, 0xffff0000, v159
  v_pk_add_f32 v[4:5], v[4:5], v[126:127]
  v_pk_fma_f32 v[6:7], v[126:127], v[126:127], v[6:7]
  s_waitcnt vmcnt(0)
  v_lshlrev_b32 v128, 16, v160
  v_and_b32 v129, 0xffff0000, v160
  v_pk_add_f32 v[4:5], v[4:5], v[128:129]
  v_pk_fma_f32 v[6:7], v[128:129], v[128:129], v[6:7]
  v_lshlrev_b32 v130, 16, v161
  v_and_b32 v131, 0xffff0000, v161
  v_pk_add_f32 v[4:5], v[4:5], v[130:131]
  v_pk_fma_f32 v[6:7], v[130:131], v[130:131], v[6:7]
  v_lshlrev_b32 v132, 16, v162
  v_and_b32 v133, 0xffff0000, v162
  v_pk_add_f32 v[4:5], v[4:5], v[132:133]
  v_pk_fma_f32 v[6:7], v[132:133], v[132:133], v[6:7]
  v_lshlrev_b32 v134, 16, v163
  v_and_b32 v135, 0xffff0000, v163
  v_pk_add_f32 v[4:5], v[4:5], v[134:135]
  v_pk_fma_f32 v[6:7], v[134:135], v[134:135], v[6:7]
  v_add_f32 v4, v4, v5
  v_add_f32 v6, v6, v7
  s_nop 0
  v_add_f32_dpp v4, v4, v4 quad_perm:[1,0,3,2] row_mask:0xf bank_mask:0xf
  v_add_f32_dpp v6, v6, v6 quad_perm:[1,0,3,2] row_mask:0xf bank_mask:0xf
  s_nop 0
  v_add_f32_dpp v4, v4, v4 quad_perm:[2,3,0,1] row_mask:0xf bank_mask:0xf
  v_add_f32_dpp v6, v6, v6 quad_perm:[2,3,0,1] row_mask:0xf bank_mask:0xf
  s_nop 0
  v_add_f32_dpp v4, v4, v4 row_half_mirror row_mask:0xf bank_mask:0xf
  v_add_f32_dpp v6, v6, v6 row_half_mirror row_mask:0xf bank_mask:0xf
  s_nop 0
  v_mul_f32 v4, 0x3b124925, v4
  v_mul_f32 v6, 0x3b124925, v6
  v_fma_f32 v6, -v4, v4, v6
  v_max_f32 v6, 0, v6
  v_cvt_pk_bf16_f32 v7, v4, v6
  v_and_b32 v6, 0xffff0000, v7
  v_add_f32 v6, 0x3727c5ac, v6
  v_cvt_pk_bf16_f32 v6, v6, v6
  v_lshlrev_b32 v6, 16, v6
  v_sqrt_f32 v6, v6
  v_lshlrev_b32 v4, 16, v7
  v_cvt_pk_bf16_f32 v6, v6, v6
  v_lshlrev_b32 v6, 16, v6
  v_rcp_f32 v6, v6
  s_nop 0
  v_mul_f32 v6, 0x3eeff558, v6
  v_mul_f32 v4, v4, v6
  .p2align 3
  v_pk_fma_f32 v[80:81], v[80:81], v[6:7], v[4:5] op_sel_hi:[1,0,0] neg_lo:[0,0,1] neg_hi:[0,0,1]
  v_pk_fma_f32 v[82:83], v[82:83], v[6:7], v[4:5] op_sel_hi:[1,0,0] neg_lo:[0,0,1] neg_hi:[0,0,1]
  v_cvt_pk_bf16_f32 v136, v80, v81
  v_pk_fma_f32 v[84:85], v[84:85], v[6:7], v[4:5] op_sel_hi:[1,0,0] neg_lo:[0,0,1] neg_hi:[0,0,1]
  v_cvt_pk_bf16_f32 v137, v82, v83
  v_pk_fma_f32 v[86:87], v[86:87], v[6:7], v[4:5] op_sel_hi:[1,0,0] neg_lo:[0,0,1] neg_hi:[0,0,1]
  v_cvt_pk_bf16_f32 v138, v84, v85
  v_pk_fma_f32 v[88:89], v[88:89], v[6:7], v[4:5] op_sel_hi:[1,0,0] neg_lo:[0,0,1] neg_hi:[0,0,1]
  v_cvt_pk_bf16_f32 v139, v86, v87
  ds_write_b128 v3, v[136:139]
  v_pk_fma_f32 v[90:91], v[90:91], v[6:7], v[4:5] op_sel_hi:[1,0,0] neg_lo:[0,0,1] neg_hi:[0,0,1]
  v_cvt_pk_bf16_f32 v140, v88, v89
  v_pk_fma_f32 v[92:93], v[92:93], v[6:7], v[4:5] op_sel_hi:[1,0,0] neg_lo:[0,0,1] neg_hi:[0,0,1]
  v_cvt_pk_bf16_f32 v141, v90, v91
  v_pk_fma_f32 v[94:95], v[94:95], v[6:7], v[4:5] op_sel_hi:[1,0,0] neg_lo:[0,0,1] neg_hi:[0,0,1]
  v_cvt_pk_bf16_f32 v142, v92, v93
  v_pk_fma_f32 v[96:97], v[96:97], v[6:7], v[4:5] op_sel_hi:[1,0,0] neg_lo:[0,0,1] neg_hi:[0,0,1]
  v_cvt_pk_bf16_f32 v143, v94, v95
  ds_write_b128 v40, v[140:143]
  v_pk_fma_f32 v[98:99], v[98:99], v[6:7], v[4:5] op_sel_hi:[1,0,0] neg_lo:[0,0,1] neg_hi:[0,0,1]
  v_cvt_pk_bf16_f32 v144, v96, v97
  v_pk_fma_f32 v[100:101], v[100:101], v[6:7], v[4:5] op_sel_hi:[1,0,0] neg_lo:[0,0,1] neg_hi:[0,0,1]
  v_cvt_pk_bf16_f32 v145, v98, v99
  v_pk_fma_f32 v[102:103], v[102:103], v[6:7], v[4:5] op_sel_hi:[1,0,0] neg_lo:[0,0,1] neg_hi:[0,0,1]
  v_cvt_pk_bf16_f32 v146, v100, v101
  v_pk_fma_f32 v[104:105], v[104:105], v[6:7], v[4:5] op_sel_hi:[1,0,0] neg_lo:[0,0,1] neg_hi:[0,0,1]
  v_cvt_pk_bf16_f32 v147, v102, v103
  ds_write_b128 v41, v[144:147]
  v_pk_fma_f32 v[106:107], v[106:107], v[6:7], v[4:5] op_sel_hi:[1,0,0] neg_lo:[0,0,1] neg_hi:[0,0,1]
  v_cvt_pk_bf16_f32 v148, v104, v105
  v_pk_fma_f32 v[108:109], v[108:109], v[6:7], v[4:5] op_sel_hi:[1,0,0] neg_lo:[0,0,1] neg_hi:[0,0,1]
  v_cvt_pk_bf16_f32 v149, v106, v107
  v_pk_fma_f32 v[110:111], v[110:111], v[6:7], v[4:5] op_sel_hi:[1,0,0] neg_lo:[0,0,1] neg_hi:[0,0,1]
  v_cvt_pk_bf16_f32 v150, v108, v109
  v_pk_fma_f32 v[112:113], v[112:113], v[6:7], v[4:5] op_sel_hi:[1,0,0] neg_lo:[0,0,1] neg_hi:[0,0,1]
  v_cvt_pk_bf16_f32 v151, v110, v111
  ds_write_b128 v42, v[148:151]
  v_pk_fma_f32 v[114:115], v[114:115], v[6:7], v[4:5] op_sel_hi:[1,0,0] neg_lo:[0,0,1] neg_hi:[0,0,1]
  v_cvt_pk_bf16_f32 v152, v112, v113
  v_pk_fma_f32 v[116:117], v[116:117], v[6:7], v[4:5] op_sel_hi:[1,0,0] neg_lo:[0,0,1] neg_hi:[0,0,1]
  v_cvt_pk_bf16_f32 v153, v114, v115
  v_pk_fma_f32 v[118:119], v[118:119], v[6:7], v[4:5] op_sel_hi:[1,0,0] neg_lo:[0,0,1] neg_hi:[0,0,1]
  v_cvt_pk_bf16_f32 v154, v116, v117
  v_pk_fma_f32 v[120:121], v[120:121], v[6:7], v[4:5] op_sel_hi:[1,0,0] neg_lo:[0,0,1] neg_hi:[0,0,1]
  v_cvt_pk_bf16_f32 v155, v118, v119
  ds_write_b128 v43, v[152:155]
  v_pk_fma_f32 v[122:123], v[122:123], v[6:7], v[4:5] op_sel_hi:[1,0,0] neg_lo:[0,0,1] neg_hi:[0,0,1]
  v_cvt_pk_bf16_f32 v156, v120, v121
  v_pk_fma_f32 v[124:125], v[124:125], v[6:7], v[4:5] op_sel_hi:[1,0,0] neg_lo:[0,0,1] neg_hi:[0,0,1]
  v_cvt_pk_bf16_f32 v157, v122, v123
  v_pk_fma_f32 v[126:127], v[126:127], v[6:7], v[4:5] op_sel_hi:[1,0,0] neg_lo:[0,0,1] neg_hi:[0,0,1]
  v_cvt_pk_bf16_f32 v158, v124, v125
  v_pk_fma_f32 v[128:129], v[128:129], v[6:7], v[4:5] op_sel_hi:[1,0,0] neg_lo:[0,0,1] neg_hi:[0,0,1]
  v_cvt_pk_bf16_f32 v159, v126, v127
  ds_write_b128 v44, v[156:159]
  v_pk_fma_f32 v[130:131], v[130:131], v[6:7], v[4:5] op_sel_hi:[1,0,0] neg_lo:[0,0,1] neg_hi:[0,0,1]
  v_cvt_pk_bf16_f32 v160, v128, v129
  v_pk_fma_f32 v[132:133], v[132:133], v[6:7], v[4:5] op_sel_hi:[1,0,0] neg_lo:[0,0,1] neg_hi:[0,0,1]
  v_cvt_pk_bf16_f32 v161, v130, v131
  v_pk_fma_f32 v[134:135], v[134:135], v[6:7], v[4:5] op_sel_hi:[1,0,0] neg_lo:[0,0,1] neg_hi:[0,0,1]
  v_cvt_pk_bf16_f32 v162, v132, v133
  v_cvt_pk_bf16_f32 v163, v134, v135
  ds_write_b128 v45, v[160:163]
  s_setprio 0
  s_waitcnt lgkmcnt(0)
  s_barrier
  s_mov_b32 s44, s24
  s_and_b32 s45, s25, 0xffff
  s_mov_b32 s46, 256
  s_mov_b32 s47, 0x20000
  s_mov_b32 s32, s26
  s_and_b32 s33, s27, 0xffff
  s_mov_b32 s34, 268435456
  s_mov_b32 s35, 0x20000
  s_mov_b32 s36, s22
  s_and_b32 s37, s23, 0xffff
  s_mov_b32 s38, 1835008
  s_mov_b32 s39, 0x20000
  s_sub_u32 s77, 0, s32
  s_and_b32 s77, s77, 0xfffff
  s_lshl_b32 s3, s70, 20
  s_add_u32 s3, s3, s77
  s_mul_i32 s77, s70, 1
  s_and_b32 s77, s77, 7
  s_xor_b32 s81, s77, s93
  s_lshl_b32 s81, s81, 10
  s_add_u32 s84, s3, s81
  s_mul_i32 s97, s65, 147456
  s_add_u32 s97, s97, s84
  s_add_u32 s84, s84, 917504
  s_add_u32 s3, s3, 917504
  v_lshrrev_b32 v6, 4, v1
  v_and_b32 v7, 15, v1
  v_xor_b32 v4, v7, v6
  v_lshlrev_b32 v5, 8, v6
  s_lshl_b32 s75, s72, 11
  v_lshl_add_u32 v8, v4, 4, v5
  v_add_u32 v8, s75, v8
  v_xor_b32 v9, 192, v8
  s_barrier
  s_buffer_load_dword s94, s[44:47], 64
  v_lshrrev_b32 v4, 5, v1
  v_bfe_u32 v5, v1, 2, 3
  v_lshl_add_u32 v4, v4, 4, v5
  v_mul_u32_u24 v4, 352, v4
  v_and_b32 v5, 3, v1
  v_lshl_add_u32 v4, v5, 3, v4
  s_mul_i32 s75, s73, 56
  s_add_u32 s75, s75, 65536
  v_add_u32 v16, s75, v4
  v_add_u32 v17, 57344, v16
  v_lshrrev_b32 v6, 4, v1
  v_and_b32 v4, 7, v1
  v_xor_b32 v4, v4, v6
  v_lshlrev_b32 v4, 4, v4
  v_lshl_add_u32 v4, v6, 7, v4
  v_add_u32 v4, 4096, v4
  v_subrev_u32 v5, 1024, v8
  s_cmp_eq_u32 s72, 0
  s_cselect_b64 vcc, -1, 0
  s_cselect_b32 s75, 64, 192
  v_cndmask_b32 v14, v5, v4, vcc
  v_xor_b32 v15, s75, v14
  v_cmp_ne_u32 vcc, 0, v6
  s_lshl_b32 s75, s72, 11
  s_lshl_b32 s76, s73, 12
  v_cndmask_b32 v18, 0, -1, vcc
  s_add_u32 s75, s75, s76
  v_add_u32 v3, s75, v2
  v_lshrrev_b32 v4, 2, v1
  v_bfe_u32 v5, v1, 3, 2
  s_lshr_b32 s77, s93, 1
  v_xor_b32 v5, s77, v5
  v_lshlrev_b32 v5, 5, v5
  v_lshl_add_u32 v5, v4, 7, v5
  v_and_b32 v4, 3, v1
  v_lshl_add_u32 v12, v4, 3, v5
  v_add_u32 v10, 65536, v12
  s_lshl_b32 s78, s69, 5
  s_mul_i32 s75, s71, 7
  s_add_u32 s78, s78, s75
  s_lshl_b32 s78, s78, 7
  s_add_u32 s78, s78, 37748736
  s_waitcnt lgkmcnt(0)
  s_mov_b32 s96, 0
  s_cmp_eq_u32 s94, 0
  s_cbranch_scc1 L_na12
L_ng13:
  s_mov_b32 s95, s94
  s_barrier
  v_and_b32 v4, 15, v1
  v_lshrrev_b32 v6, 4, v1
  v_lshlrev_b32 v6, 2, v6
  v_sub_u32 v4, v4, v6
  v_mov_b32 v7, 0xf149f2ca
  v_mov_b32 v19, 0xffff
  s_lshr_b32 s75, s70, 1
  s_or_b32 s75, s75, s72
  s_cmp_eq_u32 s75, 0
  s_cselect_b32 s76, 0, 8
  s_mov_b32 s85, 0x3f9ee1b1
  v_subrev_u32 v5, 0, v4
  v_add_u32 v6, 16, v5
  v_cmp_gt_u32 s[60:61], 8, v5
  v_cmp_gt_u32 s[40:41], 8, v6
  v_cmp_gt_u32 vcc, s76, v6
  v_cndmask_b32 v24, v7, 0, s[60:61]
  v_cndmask_b32 v20, v7, 0, s[40:41]
  v_cndmask_b32 v28, v7, 0, vcc
  v_cndmask_b32 v11, 0, v19, s[60:61]
  v_subrev_u32 v5, 1, v4
  v_add_u32 v6, 16, v5
  v_cmp_gt_u32 s[60:61], 8, v5
  v_cmp_gt_u32 s[40:41], 8, v6
  v_cmp_gt_u32 vcc, s76, v6
  v_cndmask_b32 v25, v7, 0, s[60:61]
  v_cndmask_b32 v21, v7, 0, s[40:41]
  v_cndmask_b32 v29, v7, 0, vcc
  v_cndmask_b32 v5, 0, v19, s[60:61]
  v_lshl_or_b32 v11, v5, 16, v11
  s_barrier
  s_buffer_load_dword s4, s[32:35], s78 offset:0
  s_buffer_load_dword s5, s[32:35], s78 offset:128
  s_buffer_load_dword s6, s[32:35], s78 offset:256
  s_buffer_load_dword s7, s[32:35], s78 offset:384
  s_buffer_load_dword s8, s[32:35], s78 offset:512
  s_buffer_load_dword s9, s[32:35], s78 offset:640
  s_buffer_load_dword s10, s[32:35], s78 offset:768
  s_barrier
  s_waitcnt lgkmcnt(0)
  s_mov_b32 s96, 0
L_pc14:
  s_cmp_eq_u64 s[4:5], s[94:95]
  s_cbranch_scc0 L_pr15
  s_cmp_eq_u64 s[6:7], s[94:95]
  s_cbranch_scc0 L_pr15
  s_cmp_eq_u64 s[8:9], s[94:95]
  s_cbranch_scc0 L_pr15
  s_cmp_eq_u32 s10, s94
  s_cbranch_scc0 L_pr15
L_pg16:
  s_barrier
  s_and_b32 s75, s69, 5
  s_or_b32 s75, s75, s71
  s_cbranch_scc1 L_nv17
  s_lshl_b32 s28, s69, 5
  s_add_u32 s28, s28, s70
  s_lshl_b32 s28, s28, 7
  s_add_u32 s28, s28, 37748736
  s_mov_b32 s50, 0
  s_mov_b32 s29, 0
  .p2align 5
  s_load_dword s50, s[32:33], s28 glc
L_vl18:
  s_cmp_eq_u32 s50, s94
  s_cbranch_scc1 L_vd19
  s_add_u32 s29, s29, 1
  s_cmp_lt_u32 s29, 20
  s_cbranch_scc1 L_vl18
L_vd19:
  s_add_u32 s28, s28, s32
  s_lshr_b32 s30, s28, 8
  s_xor_b32 s28, s28, s30
  s_lshl_b32 s30, s70, 9
  s_xor_b32 s28, s28, s30
  s_sub_u32 s30, 0, s29
  s_bitcmp1_b32 s28, 13
  s_cselect_b32 s30, s30, s29
  s_add_u32 s30, s30, 65568
  s_atomic_add s30, s[44:45], 128
L_nv17:
  v_subrev_u32 v5, 2, v4
  v_add_u32 v6, 16, v5
  v_cmp_gt_u32 s[60:61], 8, v5
  v_cmp_gt_u32 s[40:41], 8, v6
  v_cmp_gt_u32 vcc, s76, v6
  v_cndmask_b32 v26, v7, 0, s[60:61]
  v_cndmask_b32 v22, v7, 0, s[40:41]
  v_cndmask_b32 v30, v7, 0, vcc
  v_cndmask_b32 v13, 0, v19, s[60:61]
  v_subrev_u32 v5, 3, v4
  v_add_u32 v6, 16, v5
  v_cmp_gt_u32 s[60:61], 8, v5
  v_cmp_gt_u32 s[40:41], 8, v6
  v_cmp_gt_u32 vcc, s76, v6
  v_cndmask_b32 v27, v7, 0, s[60:61]
  v_cndmask_b32 v23, v7, 0, s[40:41]
  v_cndmask_b32 v31, v7, 0, vcc
  v_cndmask_b32 v5, 0, v19, s[60:61]
  v_lshl_or_b32 v13, v5, 16, v13
  s_barrier
  s_lshl_b32 s75, s72, 11
  s_add_u32 s75, s75, 57344
  v_add_u32 v19, s75, v2
  s_setprio 2
  ds_read_b128 v[104:107], v8 offset:0
  ds_read_b128 v[108:111], v9 offset:4608
  ds_read_b128 v[116:119], v9 offset:5632
  ds_read_b128 v[112:115], v8 offset:1024
  ds_read_b128 v[96:99], v14 offset:0
  ds_read_b128 v[100:103], v15 offset:4608
  s_barrier
  ds_read_b64_tr_b16 v[144:145], v16 offset:28672
  ds_read_b64_tr_b16 v[146:147], v16 offset:31488
  ds_read_b64_tr_b16 v[148:149], v16 offset:39936
  ds_read_b64_tr_b16 v[150:151], v16 offset:42752
  ds_read_b64_tr_b16 v[152:153], v16 offset:28696
  ds_read_b64_tr_b16 v[154:155], v16 offset:31512
  s_waitcnt lgkmcnt(4)
  v_mfma_f32_16x16x32_bf16 v[32:35], v[144:147], v[104:107], 0
  ds_read_b64_tr_b16 v[156:157], v16 offset:39960
  ds_read_b64_tr_b16 v[158:159], v16 offset:42776
  s_waitcnt lgkmcnt(4)
  v_mfma_f32_16x16x32_bf16 v[32:35], v[148:151], v[108:111], v[32:35]
  ds_read_b64_tr_b16 v[160:161], v16 offset:28784
  ds_read_b64_tr_b16 v[162:163], v16 offset:31600
  v_mfma_f32_16x16x32_bf16 v[36:39], v[148:151], v[116:119], 0
  ds_read_b64_tr_b16 v[164:165], v16 offset:40048
  v_mfma_f32_16x16x32_bf16 v[36:39], v[144:147], v[112:115], v[36:39]
  ds_read_b64_tr_b16 v[166:167], v16 offset:42864
  s_waitcnt lgkmcnt(6)
  v_mfma_f32_16x16x32_bf16 v[40:43], v[152:155], v[104:107], 0
  s_waitcnt lgkmcnt(4)
  v_mfma_f32_16x16x32_bf16 v[40:43], v[156:159], v[108:111], v[40:43]
  v_mfma_f32_16x16x32_bf16 v[44:47], v[156:159], v[116:119], 0
  ds_read_b64_tr_b16 v[148:149], v16 offset:40072
  v_mfma_f32_16x16x32_bf16 v[44:47], v[152:155], v[112:115], v[44:47]
  ds_read_b64_tr_b16 v[150:151], v16 offset:42888
  s_waitcnt lgkmcnt(4)
  v_mfma_f32_16x16x32_bf16 v[48:51], v[160:163], v[96:99], 0
  ds_read_b64_tr_b16 v[144:145], v16 offset:28808
  s_waitcnt lgkmcnt(3)
  v_mfma_f32_16x16x32_bf16 v[48:51], v[164:167], v[100:103], v[48:51]
  ds_read_b64_tr_b16 v[146:147], v16 offset:31624
  v_mfma_f32_16x16x32_bf16 v[52:55], v[164:167], v[108:111], 0
  ds_read_b128 v[136:139], v8 offset:10240
  v_mfma_f32_16x16x32_bf16 v[52:55], v[160:163], v[104:107], v[52:55]
  ds_read_b64_tr_b16 v[152:153], v16 offset:28896
  v_mfma_f32_16x16x32_bf16 v[56:59], v[160:163], v[112:115], 0
  ds_read_b64_tr_b16 v[154:155], v16 offset:31712
  v_mfma_f32_16x16x32_bf16 v[56:59], v[164:167], v[116:119], v[56:59]
  ds_read_b64_tr_b16 v[156:157], v16 offset:40160
  s_waitcnt lgkmcnt(6)
  v_mfma_f32_16x16x32_bf16 v[60:63], v[148:151], v[100:103], 0
  ds_read_b64_tr_b16 v[158:159], v16 offset:42976
  s_waitcnt lgkmcnt(5)
  v_mfma_f32_16x16x32_bf16 v[60:63], v[144:147], v[96:99], v[60:63]
  ds_read_b64_tr_b16 v[164:165], v16 offset:40184
  v_mfma_f32_16x16x32_bf16 v[64:67], v[144:147], v[104:107], 0
  ds_read_b64_tr_b16 v[166:167], v16 offset:43000
  v_mfma_f32_16x16x32_bf16 v[64:67], v[148:151], v[108:111], v[64:67]
  ds_read_b64_tr_b16 v[160:161], v16 offset:28920
  v_mfma_f32_16x16x32_bf16 v[68:71], v[148:151], v[116:119], 0
  ds_read_b64_tr_b16 v[162:163], v16 offset:31736
  v_mfma_f32_16x16x32_bf16 v[68:71], v[144:147], v[112:115], v[68:71]
  ds_read_b128 v[140:143], v9 offset:14848
  s_waitcnt lgkmcnt(7)
  v_mfma_f32_16x16x32_bf16 v[72:75], v[96:99], v[152:155], 0
  ds_read_b128 v[132:135], v9 offset:13824
  s_waitcnt lgkmcnt(6)
  v_mfma_f32_16x16x32_bf16 v[72:75], v[100:103], v[156:159], v[72:75]
  ds_read_b128 v[128:131], v8 offset:9216
  s_waitcnt lgkmcnt(3)
  s_barrier
  v_mfma_f32_16x16x32_bf16 v[76:79], v[108:111], v[156:159], 0
  ds_read_b128 v[120:123], v14 offset:9216
  v_mfma_f32_16x16x32_bf16 v[76:79], v[104:107], v[152:155], v[76:79]
  ds_read_b128 v[124:127], v15 offset:13824
  v_mfma_f32_16x16x32_bf16 v[80:83], v[112:115], v[152:155], 0
  ds_read_b64_tr_b16 v[144:145], v17 offset:0
  v_mfma_f32_16x16x32_bf16 v[80:83], v[116:119], v[156:159], v[80:83]
  ds_read_b64_tr_b16 v[146:147], v17 offset:2816
  v_mfma_f32_16x16x32_bf16 v[84:87], v[100:103], v[164:167], 0
  ds_read_b64_tr_b16 v[148:149], v17 offset:11264
  v_mfma_f32_16x16x32_bf16 v[84:87], v[96:99], v[160:163], v[84:87]
  ds_read_b64_tr_b16 v[150:151], v17 offset:14080
  v_mfma_f32_16x16x32_bf16 v[88:91], v[104:107], v[160:163], 0
  ds_read_b64_tr_b16 v[152:153], v17 offset:24
  v_mfma_f32_16x16x32_bf16 v[88:91], v[108:111], v[164:167], v[88:91]
  ds_read_b64_tr_b16 v[154:155], v17 offset:2840
  v_mfma_f32_16x16x32_bf16 v[92:95], v[116:119], v[164:167], 0
  ds_read_b64_tr_b16 v[156:157], v17 offset:11288
  v_mfma_f32_16x16x32_bf16 v[92:95], v[112:115], v[160:163], v[92:95]
  ds_read_b64_tr_b16 v[158:159], v17 offset:14104
  s_waitcnt lgkmcnt(6)
  v_mfma_f32_16x16x32_bf16 v[36:39], v[144:147], v[136:139], v[36:39]
  ds_read_b64_tr_b16 v[160:161], v17 offset:112
  s_waitcnt lgkmcnt(5)
  v_mfma_f32_16x16x32_bf16 v[36:39], v[148:151], v[140:143], v[36:39]
  ds_read_b64_tr_b16 v[162:163], v17 offset:2928
  v_mfma_f32_16x16x32_bf16 v[32:35], v[148:151], v[132:135], v[32:35]
  ds_read_b64_tr_b16 v[164:165], v17 offset:11376
  v_mfma_f32_16x16x32_bf16 v[32:35], v[144:147], v[128:131], v[32:35]
  ds_read_b64_tr_b16 v[166:167], v17 offset:14192
  s_waitcnt lgkmcnt(6)
  v_mfma_f32_16x16x32_bf16 v[40:43], v[152:155], v[128:131], v[40:43]
  s_waitcnt lgkmcnt(4)
  v_mfma_f32_16x16x32_bf16 v[40:43], v[156:159], v[132:135], v[40:43]
  v_mfma_f32_16x16x32_bf16 v[44:47], v[156:159], v[140:143], v[44:47]
  ds_read_b64_tr_b16 v[148:149], v17 offset:11400
  v_mfma_f32_16x16x32_bf16 v[44:47], v[152:155], v[136:139], v[44:47]
  ds_read_b64_tr_b16 v[150:151], v17 offset:14216
  s_waitcnt lgkmcnt(4)
  v_mfma_f32_16x16x32_bf16 v[56:59], v[160:163], v[136:139], v[56:59]
  ds_read_b64_tr_b16 v[144:145], v17 offset:136
  s_waitcnt lgkmcnt(3)
  v_mfma_f32_16x16x32_bf16 v[56:59], v[164:167], v[140:143], v[56:59]
  ds_read_b64_tr_b16 v[146:147], v17 offset:2952
  v_mfma_f32_16x16x32_bf16 v[52:55], v[164:167], v[132:135], v[52:55]
  ds_read_b128 v[112:115], v8 offset:19456
  v_mfma_f32_16x16x32_bf16 v[52:55], v[160:163], v[128:131], v[52:55]
  ds_read_b64_tr_b16 v[152:153], v17 offset:224
  v_mfma_f32_16x16x32_bf16 v[48:51], v[160:163], v[120:123], v[48:51]
  ds_read_b64_tr_b16 v[154:155], v17 offset:3040
  v_mfma_f32_16x16x32_bf16 v[48:51], v[164:167], v[124:127], v[48:51]
  ds_read_b64_tr_b16 v[156:157], v17 offset:11488
  s_waitcnt lgkmcnt(6)
  v_mfma_f32_16x16x32_bf16 v[60:63], v[148:151], v[124:127], v[60:63]
  ds_read_b64_tr_b16 v[158:159], v17 offset:14304
  s_waitcnt lgkmcnt(5)
  v_mfma_f32_16x16x32_bf16 v[60:63], v[144:147], v[120:123], v[60:63]
  ds_read_b64_tr_b16 v[164:165], v17 offset:11512
  v_mfma_f32_16x16x32_bf16 v[64:67], v[144:147], v[128:131], v[64:67]
  ds_read_b64_tr_b16 v[166:167], v17 offset:14328
  v_mfma_f32_16x16x32_bf16 v[64:67], v[148:151], v[132:135], v[64:67]
  ds_read_b64_tr_b16 v[160:161], v17 offset:248
  v_mfma_f32_16x16x32_bf16 v[68:71], v[148:151], v[140:143], v[68:71]
  ds_read_b64_tr_b16 v[162:163], v17 offset:3064
  v_mfma_f32_16x16x32_bf16 v[68:71], v[144:147], v[136:139], v[68:71]
  ds_read_b128 v[116:119], v9 offset:24064
  s_waitcnt lgkmcnt(7)
  v_mfma_f32_16x16x32_bf16 v[80:83], v[136:139], v[152:155], v[80:83]
  ds_read_b128 v[108:111], v9 offset:23040
  s_waitcnt lgkmcnt(6)
  v_mfma_f32_16x16x32_bf16 v[80:83], v[140:143], v[156:159], v[80:83]
  ds_read_b128 v[104:107], v8 offset:18432
  s_waitcnt lgkmcnt(3)
  s_barrier
  v_mfma_f32_16x16x32_bf16 v[76:79], v[132:135], v[156:159], v[76:79]
  ds_read_b128 v[96:99], v14 offset:18432
  v_mfma_f32_16x16x32_bf16 v[76:79], v[128:131], v[152:155], v[76:79]
  ds_read_b128 v[100:103], v15 offset:23040
  v_mfma_f32_16x16x32_bf16 v[72:75], v[120:123], v[152:155], v[72:75]
  ds_read_b64_tr_b16 v[144:145], v16 offset:0
  v_mfma_f32_16x16x32_bf16 v[72:75], v[124:127], v[156:159], v[72:75]
  ds_read_b64_tr_b16 v[146:147], v16 offset:2816
  v_mfma_f32_16x16x32_bf16 v[84:87], v[124:127], v[164:167], v[84:87]
  ds_read_b64_tr_b16 v[148:149], v16 offset:11264
  v_mfma_f32_16x16x32_bf16 v[84:87], v[120:123], v[160:163], v[84:87]
  ds_read_b64_tr_b16 v[150:151], v16 offset:14080
  v_mfma_f32_16x16x32_bf16 v[88:91], v[128:131], v[160:163], v[88:91]
  ds_read_b64_tr_b16 v[152:153], v16 offset:24
  v_mfma_f32_16x16x32_bf16 v[88:91], v[132:135], v[164:167], v[88:91]
  ds_read_b64_tr_b16 v[154:155], v16 offset:2840
  v_mfma_f32_16x16x32_bf16 v[92:95], v[140:143], v[164:167], v[92:95]
  ds_read_b64_tr_b16 v[156:157], v16 offset:11288
  v_mfma_f32_16x16x32_bf16 v[92:95], v[136:139], v[160:163], v[92:95]
  ds_read_b64_tr_b16 v[158:159], v16 offset:14104
  s_waitcnt lgkmcnt(6)
  v_mfma_f32_16x16x32_bf16 v[36:39], v[144:147], v[112:115], v[36:39]
  ds_read_b64_tr_b16 v[160:161], v16 offset:112
  s_waitcnt lgkmcnt(5)
  v_mfma_f32_16x16x32_bf16 v[36:39], v[148:151], v[116:119], v[36:39]
  ds_read_b64_tr_b16 v[162:163], v16 offset:2928
  v_mfma_f32_16x16x32_bf16 v[32:35], v[148:151], v[108:111], v[32:35]
  ds_read_b64_tr_b16 v[164:165], v16 offset:11376
  v_mfma_f32_16x16x32_bf16 v[32:35], v[144:147], v[104:107], v[32:35]
  ds_read_b64_tr_b16 v[166:167], v16 offset:14192
  s_waitcnt lgkmcnt(6)
  v_mfma_f32_16x16x32_bf16 v[40:43], v[152:155], v[104:107], v[40:43]
  s_waitcnt lgkmcnt(4)
  v_mfma_f32_16x16x32_bf16 v[40:43], v[156:159], v[108:111], v[40:43]
  v_mfma_f32_16x16x32_bf16 v[44:47], v[156:159], v[116:119], v[44:47]
  ds_read_b64_tr_b16 v[148:149], v16 offset:11400
  v_mfma_f32_16x16x32_bf16 v[44:47], v[152:155], v[112:115], v[44:47]
  ds_read_b64_tr_b16 v[150:151], v16 offset:14216
  s_waitcnt lgkmcnt(4)
  v_mfma_f32_16x16x32_bf16 v[56:59], v[160:163], v[112:115], v[56:59]
  ds_read_b64_tr_b16 v[144:145], v16 offset:136
  s_waitcnt lgkmcnt(3)
  v_mfma_f32_16x16x32_bf16 v[56:59], v[164:167], v[116:119], v[56:59]
  ds_read_b64_tr_b16 v[146:147], v16 offset:2952
  v_mfma_f32_16x16x32_bf16 v[52:55], v[164:167], v[108:111], v[52:55]
  ds_read_b128 v[136:139], v8 offset:28672
  v_mfma_f32_16x16x32_bf16 v[52:55], v[160:163], v[104:107], v[52:55]
  ds_read_b64_tr_b16 v[152:153], v16 offset:224
  v_mfma_f32_16x16x32_bf16 v[48:51], v[160:163], v[96:99], v[48:51]
  ds_read_b64_tr_b16 v[154:155], v16 offset:3040
  v_mfma_f32_16x16x32_bf16 v[48:51], v[164:167], v[100:103], v[48:51]
  ds_read_b64_tr_b16 v[156:157], v16 offset:11488
  s_waitcnt lgkmcnt(6)
  v_mfma_f32_16x16x32_bf16 v[60:63], v[148:151], v[100:103], v[60:63]
  ds_read_b64_tr_b16 v[158:159], v16 offset:14304
  s_waitcnt lgkmcnt(5)
  v_mfma_f32_16x16x32_bf16 v[60:63], v[144:147], v[96:99], v[60:63]
  ds_read_b64_tr_b16 v[164:165], v16 offset:11512
  v_mfma_f32_16x16x32_bf16 v[64:67], v[144:147], v[104:107], v[64:67]
  ds_read_b64_tr_b16 v[166:167], v16 offset:14328
  v_mfma_f32_16x16x32_bf16 v[64:67], v[148:151], v[108:111], v[64:67]
  ds_read_b64_tr_b16 v[160:161], v16 offset:248
  v_mfma_f32_16x16x32_bf16 v[68:71], v[148:151], v[116:119], v[68:71]
  ds_read_b64_tr_b16 v[162:163], v16 offset:3064
  v_mfma_f32_16x16x32_bf16 v[68:71], v[144:147], v[112:115], v[68:71]
  ds_read_b128 v[140:143], v9 offset:33280
  s_waitcnt lgkmcnt(7)
  v_mfma_f32_16x16x32_bf16 v[80:83], v[112:115], v[152:155], v[80:83]
  ds_read_b128 v[132:135], v9 offset:32256
  s_waitcnt lgkmcnt(6)
  v_mfma_f32_16x16x32_bf16 v[80:83], v[116:119], v[156:159], v[80:83]
  ds_read_b128 v[128:131], v8 offset:27648
  s_waitcnt lgkmcnt(3)
  s_barrier
  v_mfma_f32_16x16x32_bf16 v[76:79], v[108:111], v[156:159], v[76:79]
  ds_read_b128 v[120:123], v14 offset:27648
  v_mfma_f32_16x16x32_bf16 v[76:79], v[104:107], v[152:155], v[76:79]
  ds_read_b128 v[124:127], v15 offset:32256
  v_mfma_f32_16x16x32_bf16 v[72:75], v[96:99], v[152:155], v[72:75]
  ds_read_b64_tr_b16 v[144:145], v16 offset:28672
  v_mfma_f32_16x16x32_bf16 v[72:75], v[100:103], v[156:159], v[72:75]
  ds_read_b64_tr_b16 v[146:147], v16 offset:31488
  v_mfma_f32_16x16x32_bf16 v[84:87], v[100:103], v[164:167], v[84:87]
  ds_read_b64_tr_b16 v[148:149], v16 offset:39936
  v_mfma_f32_16x16x32_bf16 v[84:87], v[96:99], v[160:163], v[84:87]
  ds_read_b64_tr_b16 v[150:151], v16 offset:42752
  v_mfma_f32_16x16x32_bf16 v[88:91], v[104:107], v[160:163], v[88:91]
  ds_read_b64_tr_b16 v[152:153], v16 offset:28696
  v_mfma_f32_16x16x32_bf16 v[88:91], v[108:111], v[164:167], v[88:91]
  ds_read_b64_tr_b16 v[154:155], v16 offset:31512
  v_mfma_f32_16x16x32_bf16 v[92:95], v[116:119], v[164:167], v[92:95]
  ds_read_b64_tr_b16 v[156:157], v16 offset:39960
  v_mfma_f32_16x16x32_bf16 v[92:95], v[112:115], v[160:163], v[92:95]
  ds_read_b64_tr_b16 v[158:159], v16 offset:42776
  s_waitcnt lgkmcnt(6)
  v_mfma_f32_16x16x32_bf16 v[36:39], v[144:147], v[136:139], v[36:39]
  ds_read_b64_tr_b16 v[160:161], v16 offset:28784
  s_waitcnt lgkmcnt(5)
  v_mfma_f32_16x16x32_bf16 v[36:39], v[148:151], v[140:143], v[36:39]
  ds_read_b64_tr_b16 v[162:163], v16 offset:31600
  v_mfma_f32_16x16x32_bf16 v[32:35], v[148:151], v[132:135], v[32:35]
  ds_read_b64_tr_b16 v[164:165], v16 offset:40048
  v_mfma_f32_16x16x32_bf16 v[32:35], v[144:147], v[128:131], v[32:35]
  ds_read_b64_tr_b16 v[166:167], v16 offset:42864
  s_waitcnt lgkmcnt(6)
  v_mfma_f32_16x16x32_bf16 v[40:43], v[152:155], v[128:131], v[40:43]
  s_waitcnt lgkmcnt(4)
  v_mfma_f32_16x16x32_bf16 v[40:43], v[156:159], v[132:135], v[40:43]
  v_mfma_f32_16x16x32_bf16 v[44:47], v[156:159], v[140:143], v[44:47]
  ds_read_b64_tr_b16 v[148:149], v16 offset:40072
  v_mfma_f32_16x16x32_bf16 v[44:47], v[152:155], v[136:139], v[44:47]
  ds_read_b64_tr_b16 v[150:151], v16 offset:42888
  s_waitcnt lgkmcnt(4)
  v_mfma_f32_16x16x32_bf16 v[56:59], v[160:163], v[136:139], v[56:59]
  ds_read_b64_tr_b16 v[144:145], v16 offset:28808
  s_waitcnt lgkmcnt(3)
  v_mfma_f32_16x16x32_bf16 v[56:59], v[164:167], v[140:143], v[56:59]
  ds_read_b64_tr_b16 v[146:147], v16 offset:31624
  v_mfma_f32_16x16x32_bf16 v[52:55], v[164:167], v[132:135], v[52:55]
  ds_read_b128 v[112:115], v8 offset:37888
  v_mfma_f32_16x16x32_bf16 v[52:55], v[160:163], v[128:131], v[52:55]
  ds_read_b64_tr_b16 v[152:153], v16 offset:28896
  v_mfma_f32_16x16x32_bf16 v[48:51], v[160:163], v[120:123], v[48:51]
  ds_read_b64_tr_b16 v[154:155], v16 offset:31712
  v_mfma_f32_16x16x32_bf16 v[48:51], v[164:167], v[124:127], v[48:51]
  ds_read_b64_tr_b16 v[156:157], v16 offset:40160
  s_waitcnt lgkmcnt(6)
  v_mfma_f32_16x16x32_bf16 v[60:63], v[148:151], v[124:127], v[60:63]
  ds_read_b64_tr_b16 v[158:159], v16 offset:42976
  s_waitcnt lgkmcnt(5)
  v_mfma_f32_16x16x32_bf16 v[60:63], v[144:147], v[120:123], v[60:63]
  ds_read_b64_tr_b16 v[164:165], v16 offset:40184
  v_mfma_f32_16x16x32_bf16 v[64:67], v[144:147], v[128:131], v[64:67]
  ds_read_b64_tr_b16 v[166:167], v16 offset:43000
  v_mfma_f32_16x16x32_bf16 v[64:67], v[148:151], v[132:135], v[64:67]
  ds_read_b64_tr_b16 v[160:161], v16 offset:28920
  v_mfma_f32_16x16x32_bf16 v[68:71], v[148:151], v[140:143], v[68:71]
  ds_read_b64_tr_b16 v[162:163], v16 offset:31736
  v_mfma_f32_16x16x32_bf16 v[68:71], v[144:147], v[136:139], v[68:71]
  ds_read_b128 v[116:119], v9 offset:42496
  s_waitcnt lgkmcnt(7)
  v_mfma_f32_16x16x32_bf16 v[80:83], v[136:139], v[152:155], v[80:83]
  ds_read_b128 v[108:111], v9 offset:41472
  s_waitcnt lgkmcnt(6)
  v_mfma_f32_16x16x32_bf16 v[80:83], v[140:143], v[156:159], v[80:83]
  ds_read_b128 v[104:107], v8 offset:36864
  s_waitcnt lgkmcnt(3)
  s_barrier
  v_mfma_f32_16x16x32_bf16 v[76:79], v[132:135], v[156:159], v[76:79]
  ds_read_b128 v[96:99], v14 offset:36864
  v_mfma_f32_16x16x32_bf16 v[76:79], v[128:131], v[152:155], v[76:79]
  ds_read_b128 v[100:103], v15 offset:41472
  v_mfma_f32_16x16x32_bf16 v[72:75], v[120:123], v[152:155], v[72:75]
  ds_read_b64_tr_b16 v[144:145], v17 offset:0
  v_mfma_f32_16x16x32_bf16 v[72:75], v[124:127], v[156:159], v[72:75]
  ds_read_b64_tr_b16 v[146:147], v17 offset:2816
  v_mfma_f32_16x16x32_bf16 v[84:87], v[124:127], v[164:167], v[84:87]
  ds_read_b64_tr_b16 v[148:149], v17 offset:11264
  v_mfma_f32_16x16x32_bf16 v[84:87], v[120:123], v[160:163], v[84:87]
  ds_read_b64_tr_b16 v[150:151], v17 offset:14080
  v_mfma_f32_16x16x32_bf16 v[88:91], v[128:131], v[160:163], v[88:91]
  ds_read_b64_tr_b16 v[152:153], v17 offset:24
  v_mfma_f32_16x16x32_bf16 v[88:91], v[132:135], v[164:167], v[88:91]
  ds_read_b64_tr_b16 v[154:155], v17 offset:2840
  v_mfma_f32_16x16x32_bf16 v[92:95], v[140:143], v[164:167], v[92:95]
  ds_read_b64_tr_b16 v[156:157], v17 offset:11288
  v_mfma_f32_16x16x32_bf16 v[92:95], v[136:139], v[160:163], v[92:95]
  ds_read_b64_tr_b16 v[158:159], v17 offset:14104
  s_waitcnt lgkmcnt(6)
  v_mfma_f32_16x16x32_bf16 v[36:39], v[144:147], v[112:115], v[36:39]
  ds_read_b64_tr_b16 v[160:161], v17 offset:112
  s_waitcnt lgkmcnt(5)
  v_mfma_f32_16x16x32_bf16 v[36:39], v[148:151], v[116:119], v[36:39]
  ds_read_b64_tr_b16 v[162:163], v17 offset:2928
  v_mfma_f32_16x16x32_bf16 v[32:35], v[148:151], v[108:111], v[32:35]
  ds_read_b64_tr_b16 v[164:165], v17 offset:11376
  v_mfma_f32_16x16x32_bf16 v[32:35], v[144:147], v[104:107], v[32:35]
  ds_read_b64_tr_b16 v[166:167], v17 offset:14192
  s_waitcnt lgkmcnt(6)
  v_mfma_f32_16x16x32_bf16 v[40:43], v[152:155], v[104:107], v[40:43]
  s_waitcnt lgkmcnt(4)
  v_mfma_f32_16x16x32_bf16 v[40:43], v[156:159], v[108:111], v[40:43]
  v_mfma_f32_16x16x32_bf16 v[44:47], v[156:159], v[116:119], v[44:47]
  ds_read_b64_tr_b16 v[148:149], v17 offset:11400
  v_mfma_f32_16x16x32_bf16 v[44:47], v[152:155], v[112:115], v[44:47]
  ds_read_b64_tr_b16 v[150:151], v17 offset:14216
  s_waitcnt lgkmcnt(4)
  v_mfma_f32_16x16x32_bf16 v[56:59], v[160:163], v[112:115], v[56:59]
  ds_read_b64_tr_b16 v[144:145], v17 offset:136
  s_waitcnt lgkmcnt(3)
  v_mfma_f32_16x16x32_bf16 v[56:59], v[164:167], v[116:119], v[56:59]
  ds_read_b64_tr_b16 v[146:147], v17 offset:2952
  v_mfma_f32_16x16x32_bf16 v[52:55], v[164:167], v[108:111], v[52:55]
  ds_read_b128 v[136:139], v8 offset:47104
  v_mfma_f32_16x16x32_bf16 v[52:55], v[160:163], v[104:107], v[52:55]
  ds_read_b64_tr_b16 v[152:153], v17 offset:224
  v_mfma_f32_16x16x32_bf16 v[48:51], v[160:163], v[96:99], v[48:51]
  ds_read_b64_tr_b16 v[154:155], v17 offset:3040
  v_mfma_f32_16x16x32_bf16 v[48:51], v[164:167], v[100:103], v[48:51]
  ds_read_b64_tr_b16 v[156:157], v17 offset:11488
  s_waitcnt lgkmcnt(6)
  v_mfma_f32_16x16x32_bf16 v[60:63], v[148:151], v[100:103], v[60:63]
  ds_read_b64_tr_b16 v[158:159], v17 offset:14304
  s_waitcnt lgkmcnt(5)
  v_mfma_f32_16x16x32_bf16 v[60:63], v[144:147], v[96:99], v[60:63]
  ds_read_b64_tr_b16 v[164:165], v17 offset:11512
  v_mfma_f32_16x16x32_bf16 v[64:67], v[144:147], v[104:107], v[64:67]
  ds_read_b64_tr_b16 v[166:167], v17 offset:14328
  v_mfma_f32_16x16x32_bf16 v[64:67], v[148:151], v[108:111], v[64:67]
  ds_read_b64_tr_b16 v[160:161], v17 offset:248
  v_mfma_f32_16x16x32_bf16 v[68:71], v[148:151], v[116:119], v[68:71]
  ds_read_b64_tr_b16 v[162:163], v17 offset:3064
  v_mfma_f32_16x16x32_bf16 v[68:71], v[144:147], v[112:115], v[68:71]
  ds_read_b128 v[140:143], v9 offset:51712
  s_waitcnt lgkmcnt(7)
  v_mfma_f32_16x16x32_bf16 v[80:83], v[112:115], v[152:155], v[80:83]
  ds_read_b128 v[132:135], v9 offset:50688
  s_waitcnt lgkmcnt(6)
  v_mfma_f32_16x16x32_bf16 v[80:83], v[116:119], v[156:159], v[80:83]
  ds_read_b128 v[128:131], v8 offset:46080
  s_waitcnt lgkmcnt(3)
  s_barrier
  v_mfma_f32_16x16x32_bf16 v[76:79], v[108:111], v[156:159], v[76:79]
  ds_read_b128 v[120:123], v14 offset:46080
  v_mfma_f32_16x16x32_bf16 v[76:79], v[104:107], v[152:155], v[76:79]
  ds_read_b128 v[124:127], v15 offset:50688
  v_mfma_f32_16x16x32_bf16 v[72:75], v[96:99], v[152:155], v[72:75]
  ds_read_b64_tr_b16 v[144:145], v16 offset:0
  v_mfma_f32_16x16x32_bf16 v[72:75], v[100:103], v[156:159], v[72:75]
  ds_read_b64_tr_b16 v[146:147], v16 offset:2816
  v_mfma_f32_16x16x32_bf16 v[84:87], v[100:103], v[164:167], v[84:87]
  ds_read_b64_tr_b16 v[148:149], v16 offset:11264
  v_mfma_f32_16x16x32_bf16 v[84:87], v[96:99], v[160:163], v[84:87]
  ds_read_b64_tr_b16 v[150:151], v16 offset:14080
  v_mfma_f32_16x16x32_bf16 v[88:91], v[104:107], v[160:163], v[88:91]
  ds_read_b64_tr_b16 v[152:153], v16 offset:24
  v_mfma_f32_16x16x32_bf16 v[88:91], v[108:111], v[164:167], v[88:91]
  ds_read_b64_tr_b16 v[154:155], v16 offset:2840
  v_mfma_f32_16x16x32_bf16 v[92:95], v[116:119], v[164:167], v[92:95]
  ds_read_b64_tr_b16 v[156:157], v16 offset:11288
  v_mfma_f32_16x16x32_bf16 v[92:95], v[112:115], v[160:163], v[92:95]
  ds_read_b64_tr_b16 v[158:159], v16 offset:14104
  s_waitcnt lgkmcnt(6)
  v_mfma_f32_16x16x32_bf16 v[36:39], v[144:147], v[136:139], v[36:39]
  ds_read_b64_tr_b16 v[160:161], v16 offset:112
  s_waitcnt lgkmcnt(5)
  v_mfma_f32_16x16x32_bf16 v[36:39], v[148:151], v[140:143], v[36:39]
  ds_read_b64_tr_b16 v[162:163], v16 offset:2928
  v_mfma_f32_16x16x32_bf16 v[32:35], v[148:151], v[132:135], v[32:35]
  ds_read_b64_tr_b16 v[164:165], v16 offset:11376
  v_mfma_f32_16x16x32_bf16 v[32:35], v[144:147], v[128:131], v[32:35]
  ds_read_b64_tr_b16 v[166:167], v16 offset:14192
  s_waitcnt lgkmcnt(6)
  v_mfma_f32_16x16x32_bf16 v[40:43], v[152:155], v[128:131], v[40:43]
  s_waitcnt lgkmcnt(4)
  v_mfma_f32_16x16x32_bf16 v[40:43], v[156:159], v[132:135], v[40:43]
  v_mfma_f32_16x16x32_bf16 v[44:47], v[156:159], v[140:143], v[44:47]
  ds_read_b64_tr_b16 v[148:149], v16 offset:11400
  v_mfma_f32_16x16x32_bf16 v[44:47], v[152:155], v[136:139], v[44:47]
  ds_read_b64_tr_b16 v[150:151], v16 offset:14216
  s_waitcnt lgkmcnt(4)
  v_mfma_f32_16x16x32_bf16 v[56:59], v[160:163], v[136:139], v[56:59]
  ds_read_b64_tr_b16 v[144:145], v16 offset:136
  s_waitcnt lgkmcnt(3)
  v_mfma_f32_16x16x32_bf16 v[56:59], v[164:167], v[140:143], v[56:59]
  ds_read_b64_tr_b16 v[146:147], v16 offset:2952
  v_mfma_f32_16x16x32_bf16 v[52:55], v[164:167], v[132:135], v[52:55]
  ds_read_b128 v[112:115], v8 offset:56320
  v_mfma_f32_16x16x32_bf16 v[52:55], v[160:163], v[128:131], v[52:55]
  ds_read_b64_tr_b16 v[152:153], v16 offset:224
  v_mfma_f32_16x16x32_bf16 v[48:51], v[160:163], v[120:123], v[48:51]
  ds_read_b64_tr_b16 v[154:155], v16 offset:3040
  v_mfma_f32_16x16x32_bf16 v[48:51], v[164:167], v[124:127], v[48:51]
  ds_read_b64_tr_b16 v[156:157], v16 offset:11488
  s_waitcnt lgkmcnt(6)
  v_mfma_f32_16x16x32_bf16 v[60:63], v[148:151], v[124:127], v[60:63]
  ds_read_b64_tr_b16 v[158:159], v16 offset:14304
  s_waitcnt lgkmcnt(5)
  v_mfma_f32_16x16x32_bf16 v[60:63], v[144:147], v[120:123], v[60:63]
  ds_read_b64_tr_b16 v[164:165], v16 offset:11512
  v_mfma_f32_16x16x32_bf16 v[64:67], v[144:147], v[128:131], v[64:67]
  ds_read_b64_tr_b16 v[166:167], v16 offset:14328
  v_mfma_f32_16x16x32_bf16 v[64:67], v[148:151], v[132:135], v[64:67]
  ds_read_b64_tr_b16 v[160:161], v16 offset:248
  v_mfma_f32_16x16x32_bf16 v[68:71], v[148:151], v[140:143], v[68:71]
  ds_read_b64_tr_b16 v[162:163], v16 offset:3064
  v_mfma_f32_16x16x32_bf16 v[68:71], v[144:147], v[136:139], v[68:71]
  ds_read_b128 v[116:119], v9 offset:60928
  s_waitcnt lgkmcnt(7)
  v_mfma_f32_16x16x32_bf16 v[80:83], v[136:139], v[152:155], v[80:83]
  ds_read_b128 v[108:111], v9 offset:59904
  s_waitcnt lgkmcnt(6)
  v_mfma_f32_16x16x32_bf16 v[80:83], v[140:143], v[156:159], v[80:83]
  ds_read_b128 v[104:107], v8 offset:55296
  s_waitcnt lgkmcnt(3)
  s_barrier
  v_mfma_f32_16x16x32_bf16 v[76:79], v[132:135], v[156:159], v[76:79]
  ds_read_b128 v[96:99], v14 offset:55296
  v_mfma_f32_16x16x32_bf16 v[76:79], v[128:131], v[152:155], v[76:79]
  ds_read_b128 v[100:103], v15 offset:59904
  v_mfma_f32_16x16x32_bf16 v[72:75], v[120:123], v[152:155], v[72:75]
  ds_read_b64_tr_b16 v[144:145], v16 offset:28672
  v_mfma_f32_16x16x32_bf16 v[72:75], v[124:127], v[156:159], v[72:75]
  ds_read_b64_tr_b16 v[146:147], v16 offset:31488
  v_mfma_f32_16x16x32_bf16 v[84:87], v[124:127], v[164:167], v[84:87]
  ds_read_b64_tr_b16 v[148:149], v16 offset:39936
  v_mfma_f32_16x16x32_bf16 v[84:87], v[120:123], v[160:163], v[84:87]
  ds_read_b64_tr_b16 v[150:151], v16 offset:42752
  v_mfma_f32_16x16x32_bf16 v[88:91], v[128:131], v[160:163], v[88:91]
  ds_read_b64_tr_b16 v[152:153], v16 offset:28696
  v_mfma_f32_16x16x32_bf16 v[88:91], v[132:135], v[164:167], v[88:91]
  ds_read_b64_tr_b16 v[154:155], v16 offset:31512
  v_mfma_f32_16x16x32_bf16 v[92:95], v[140:143], v[164:167], v[92:95]
  ds_read_b64_tr_b16 v[156:157], v16 offset:39960
  v_mfma_f32_16x16x32_bf16 v[92:95], v[136:139], v[160:163], v[92:95]
  ds_read_b64_tr_b16 v[158:159], v16 offset:42776
  s_waitcnt lgkmcnt(6)
  v_mfma_f32_16x16x32_bf16 v[36:39], v[144:147], v[112:115], v[36:39]
  ds_read_b64_tr_b16 v[160:161], v16 offset:28784
  s_waitcnt lgkmcnt(5)
  v_mfma_f32_16x16x32_bf16 v[36:39], v[148:151], v[116:119], v[36:39]
  ds_read_b64_tr_b16 v[162:163], v16 offset:31600
  v_mfma_f32_16x16x32_bf16 v[32:35], v[148:151], v[108:111], v[32:35]
  ds_read_b64_tr_b16 v[164:165], v16 offset:40048
  v_mfma_f32_16x16x32_bf16 v[32:35], v[144:147], v[104:107], v[32:35]
  ds_read_b64_tr_b16 v[166:167], v16 offset:42864
  s_waitcnt lgkmcnt(6)
  v_mfma_f32_16x16x32_bf16 v[40:43], v[152:155], v[104:107], v[40:43]
  s_waitcnt lgkmcnt(4)
  v_mfma_f32_16x16x32_bf16 v[40:43], v[156:159], v[108:111], v[40:43]
  v_mfma_f32_16x16x32_bf16 v[44:47], v[156:159], v[116:119], v[44:47]
  ds_read_b64_tr_b16 v[148:149], v16 offset:40072
  v_mfma_f32_16x16x32_bf16 v[44:47], v[152:155], v[112:115], v[44:47]
  ds_read_b64_tr_b16 v[150:151], v16 offset:42888
  s_waitcnt lgkmcnt(4)
  v_mfma_f32_16x16x32_bf16 v[56:59], v[160:163], v[112:115], v[56:59]
  ds_read_b64_tr_b16 v[144:145], v16 offset:28808
  s_waitcnt lgkmcnt(3)
  v_mfma_f32_16x16x32_bf16 v[56:59], v[164:167], v[116:119], v[56:59]
  ds_read_b64_tr_b16 v[146:147], v16 offset:31624
  v_mfma_f32_16x16x32_bf16 v[52:55], v[164:167], v[108:111], v[52:55]
  v_mfma_f32_16x16x32_bf16 v[52:55], v[160:163], v[104:107], v[52:55]
  ds_read_b64_tr_b16 v[152:153], v16 offset:28896
  v_mfma_f32_16x16x32_bf16 v[48:51], v[160:163], v[96:99], v[48:51]
  ds_read_b64_tr_b16 v[154:155], v16 offset:31712
  v_mfma_f32_16x16x32_bf16 v[48:51], v[164:167], v[100:103], v[48:51]
  ds_read_b64_tr_b16 v[156:157], v16 offset:40160
  s_waitcnt lgkmcnt(5)
  v_mfma_f32_16x16x32_bf16 v[60:63], v[148:151], v[100:103], v[60:63]
  ds_read_b64_tr_b16 v[158:159], v16 offset:42976
  v_mov_b32 v128, 0x3f803f80
  v_mov_b32 v129, 0x3f803f80
  s_waitcnt lgkmcnt(4)
  v_mfma_f32_16x16x32_bf16 v[60:63], v[144:147], v[96:99], v[60:63]
  ds_read_b64_tr_b16 v[164:165], v16 offset:40184
  v_mov_b32 v130, 0x3f803f80
  v_mov_b32 v131, 0x3f803f80
  v_mfma_f32_16x16x32_bf16 v[64:67], v[144:147], v[104:107], v[64:67]
  ds_read_b64_tr_b16 v[166:167], v16 offset:43000
  v_cvt_pk_bf16_f32 v120, v32, v33
  v_cvt_pk_bf16_f32 v121, v34, v35
  v_mfma_f32_16x16x32_bf16 v[64:67], v[148:151], v[108:111], v[64:67]
  ds_read_b64_tr_b16 v[160:161], v16 offset:28920
  v_cvt_pk_bf16_f32 v124, v36, v37
  v_cvt_pk_bf16_f32 v125, v38, v39
  v_mfma_f32_16x16x32_bf16 v[68:71], v[148:151], v[116:119], v[68:71]
  ds_read_b64_tr_b16 v[162:163], v16 offset:31736
  v_cvt_pk_bf16_f32 v122, v40, v41
  v_cvt_pk_bf16_f32 v123, v42, v43
  v_mfma_f32_16x16x32_bf16 v[68:71], v[144:147], v[112:115], v[68:71]
  v_cvt_pk_bf16_f32 v126, v44, v45
  v_cvt_pk_bf16_f32 v127, v46, v47
  s_waitcnt lgkmcnt(6)
  v_mfma_f32_16x16x32_bf16 v[80:83], v[112:115], v[152:155], v[80:83]
  v_and_b32 v122, v18, v122
  v_and_b32 v123, v18, v123
  s_waitcnt lgkmcnt(4)
  v_mfma_f32_16x16x32_bf16 v[80:83], v[116:119], v[156:159], v[80:83]
  v_and_b32 v126, v18, v126
  v_and_b32 v127, v18, v127
  s_waitcnt lgkmcnt(0)
  s_barrier
  v_mfma_f32_16x16x32_bf16 v[76:79], v[108:111], v[156:159], v[76:79]
  v_cvt_pk_bf16_f32 v132, v48, v49
  v_cvt_pk_bf16_f32 v133, v50, v51
  v_mfma_f32_16x16x32_bf16 v[76:79], v[104:107], v[152:155], v[76:79]
  v_cvt_pk_bf16_f32 v136, v52, v53
  v_cvt_pk_bf16_f32 v137, v54, v55
  v_mfma_f32_16x16x32_bf16 v[72:75], v[96:99], v[152:155], v[72:75]
  v_cvt_pk_bf16_f32 v140, v56, v57
  v_cvt_pk_bf16_f32 v141, v58, v59
  v_mfma_f32_16x16x32_bf16 v[72:75], v[100:103], v[156:159], v[72:75]
  v_cvt_pk_bf16_f32 v134, v60, v61
  v_cvt_pk_bf16_f32 v135, v62, v63
  v_mfma_f32_16x16x32_bf16 v[84:87], v[100:103], v[164:167], v[84:87]
  v_cvt_pk_bf16_f32 v138, v64, v65
  v_cvt_pk_bf16_f32 v139, v66, v67
  v_mfma_f32_16x16x32_bf16 v[84:87], v[96:99], v[160:163], v[84:87]
  v_cvt_pk_bf16_f32 v142, v68, v69
  v_cvt_pk_bf16_f32 v143, v70, v71
  v_mfma_f32_16x16x32_bf16 v[88:91], v[104:107], v[160:163], v[88:91]
  v_mfma_f32_16x16x32_bf16 v[88:91], v[108:111], v[164:167], v[88:91]
  v_mfma_f32_16x16x32_bf16 v[32:35], v[132:135], v[120:123], v[28:31]
  v_mfma_f32_16x16x32_bf16 v[36:39], v[136:139], v[120:123], v[24:27]
  v_mfma_f32_16x16x32_bf16 v[40:43], v[136:139], v[124:127], v[20:23]
  v_mfma_f32_16x16x32_bf16 v[44:47], v[140:143], v[124:127], v[24:27]
  v_mfma_f32_16x16x32_bf16 v[92:95], v[116:119], v[164:167], v[92:95]
  v_mfma_f32_16x16x32_bf16 v[92:95], v[112:115], v[160:163], v[92:95]
  v_cvt_pk_bf16_f32 v72, v72, v73
  v_cvt_pk_bf16_f32 v73, v74, v75
  v_cvt_pk_bf16_f32 v74, v76, v77
  v_cvt_pk_bf16_f32 v75, v78, v79
  v_max_f32 v64, v32, v36
  v_max_f32 v65, v33, v37
  v_max_f32 v66, v34, v38
  v_max_f32 v67, v35, v39
  v_max_f32 v68, v40, v44
  v_max_f32 v69, v41, v45
  v_max_f32 v70, v42, v46
  v_max_f32 v71, v43, v47
  v_max3_f32 v4, v64, v65, v66
  v_max3_f32 v5, v68, v69, v70
  v_max_f32 v4, v4, v67
  v_max_f32 v5, v5, v71
  v_cvt_pk_bf16_f32 v76, v80, v81
  v_cvt_pk_bf16_f32 v77, v82, v83
  v_permlane32_swap_b32 v4, v5
  v_cvt_pk_bf16_f32 v78, v84, v85
  v_max_f32 v4, v4, v5
  v_mov_b32 v5, v4
  v_cvt_pk_bf16_f32 v79, v86, v87
  v_cvt_pk_bf16_f32 v80, v88, v89
  v_permlane16_swap_b32 v4, v5
  v_cvt_pk_bf16_f32 v81, v90, v91
  v_max_f32 v4, v4, v5
  v_mul_f32 v5, s85, v4
  v_mul_f32 v4, s85, v4
  v_cvt_pk_bf16_f32 v82, v92, v93
  v_cvt_pk_bf16_f32 v83, v94, v95
  v_permlane32_swap_b32 v4, v5
  s_nop 0
  v_fma_f32 v64, v64, s85, -v4
  v_fma_f32 v65, v65, s85, -v4
  v_fma_f32 v66, v66, s85, -v4
  v_fma_f32 v67, v67, s85, -v4
  v_exp_f32 v64, v64
  v_exp_f32 v65, v65
  v_exp_f32 v66, v66
  v_exp_f32 v67, v67
  v_cvt_pk_bf16_f32 v64, v64, v65
  v_cvt_pk_bf16_f32 v66, v66, v67
  v_bfi_b32 v48, v11, 0, v64
  v_bfi_b32 v49, v13, 0, v66
  v_and_b32 v50, v11, v64
  v_and_b32 v51, v13, v66
  s_nop 1
  v_mfma_f32_16x16x32_bf16 v[160:163], v[128:131], v[48:51], 0
  v_mfma_f32_16x16x32_bf16 v[32:35], v[72:75], v[48:51], 0
  v_mfma_f32_16x16x32_bf16 v[36:39], v[78:81], v[48:51], 0
  v_fma_f32 v68, v68, s85, -v5
  v_fma_f32 v69, v69, s85, -v5
  v_fma_f32 v70, v70, s85, -v5
  v_fma_f32 v71, v71, s85, -v5
  v_exp_f32 v68, v68
  v_exp_f32 v69, v69
  s_barrier
  v_exp_f32 v70, v70
  ds_read_b128 v[96:99], v19 offset:36864
  v_exp_f32 v71, v71
  v_cvt_pk_bf16_f32 v68, v68, v69
  ds_read_b128 v[132:135], v19 offset:37888
  v_cvt_pk_bf16_f32 v70, v70, v71
  v_bfi_b32 v52, v11, 0, v68
  ds_read_b128 v[100:103], v19 offset:40960
  v_bfi_b32 v53, v13, 0, v70
  v_and_b32 v54, v11, v68
  ds_read_b128 v[136:139], v19 offset:41984
  v_and_b32 v55, v13, v70
  v_add_u32 v11, 122880, v12
  ds_read_b128 v[104:107], v19 offset:45056
  v_xor_b32 v13, 64, v12
  v_mfma_f32_16x16x32_bf16 v[164:167], v[128:131], v[52:55], 0
  ds_read_b128 v[140:143], v19 offset:46080
  v_mfma_f32_16x16x32_bf16 v[40:43], v[74:77], v[52:55], 0
  v_mfma_f32_16x16x32_bf16 v[44:47], v[80:83], v[52:55], 0
  ds_read_b128 v[108:111], v19 offset:49152
  v_rcp_f32 v160, v160
  s_nop 0
  v_mul_f32 v160, 0x40088e99, v160
  ds_read_b128 v[144:147], v19 offset:50176
  v_and_b32 v161, v18, v160
  v_mul_f32 v32, v160, v32
  ds_read_b128 v[112:115], v19 offset:53248
  v_mul_f32 v33, v160, v33
  v_mul_f32 v34, v160, v34
  ds_read_b128 v[148:151], v19 offset:54272
  v_mul_f32 v35, v160, v35
  v_mul_f32 v36, v161, v36
  ds_read_b128 v[116:119], v19 offset:57344
  v_mul_f32 v37, v161, v37
  v_mul_f32 v38, v161, v38
  ds_read_b128 v[152:155], v19 offset:58368
  v_mul_f32 v39, v161, v39
  v_cvt_pk_bf16_f32 v56, v32, v33
  ds_read_b128 v[120:123], v19 offset:61440
  v_cvt_pk_bf16_f32 v57, v34, v35
  v_cvt_pk_bf16_f32 v58, v36, v37
  ds_read_b128 v[156:159], v19 offset:62464
  v_cvt_pk_bf16_f32 v59, v38, v39
  v_rcp_f32 v164, v164
  s_nop 0
  v_mul_f32 v164, 0x40088e99, v164
  v_and_b32 v165, v18, v164
  v_mul_f32 v40, v164, v40
  v_mul_f32 v41, v164, v41
  v_mul_f32 v42, v164, v42
  v_mul_f32 v43, v164, v43
  v_mul_f32 v44, v165, v44
  v_mul_f32 v45, v165, v45
  v_mul_f32 v46, v165, v46
  v_mul_f32 v47, v165, v47
  v_cvt_pk_bf16_f32 v60, v40, v41
  v_cvt_pk_bf16_f32 v61, v42, v43
  v_cvt_pk_bf16_f32 v62, v44, v45
  v_cvt_pk_bf16_f32 v63, v46, v47
  ds_write_b128 v3, v[56:59] offset:57344
  ds_write_b128 v3, v[60:63] offset:58368
  s_setprio 2
  s_lshl_b32 s75, s72, 11
  s_add_u32 s75, s75, 57344
  v_add_u32 v3, s75, v2
  s_waitcnt lgkmcnt(0)
  s_barrier
  v_mov_b32 v7, 161924
  ds_read_b32 v7, v7
  ds_read_b64_tr_b16 v[44:45], v12 offset:0
  ds_read_b64_tr_b16 v[46:47], v12 offset:2048
  ds_read_b64_tr_b16 v[48:49], v12 offset:4096
  ds_read_b64_tr_b16 v[50:51], v12 offset:6144
  ds_read_b64_tr_b16 v[52:53], v12 offset:8192
  ds_read_b64_tr_b16 v[54:55], v12 offset:10240
  ds_read_b64_tr_b16 v[56:57], v12 offset:14336
  ds_read_b64_tr_b16 v[58:59], v12 offset:16384
  ds_read_b64_tr_b16 v[60:61], v12 offset:18432
  ds_read_b64_tr_b16 v[62:63], v12 offset:20480
  s_waitcnt lgkmcnt(8)
  v_mfma_f32_16x16x32_bf16 v[28:31], v[44:47], v[96:99], 0
  ds_read_b64_tr_b16 v[64:65], v12 offset:22528
  ds_read_b64_tr_b16 v[66:67], v12 offset:24576
  v_mfma_f32_16x16x32_bf16 v[32:35], v[44:47], v[132:135], 0
  ds_read_b64_tr_b16 v[44:45], v12 offset:12288
  ds_read_b64_tr_b16 v[46:47], v12 offset:26624
  s_waitcnt lgkmcnt(10)
  v_mfma_f32_16x16x32_bf16 v[32:35], v[48:51], v[136:139], v[32:35]
  ds_read_b128 v[124:127], v3 offset:0
  ds_read_b128 v[160:163], v3 offset:1024
  v_mfma_f32_16x16x32_bf16 v[28:31], v[48:51], v[100:103], v[28:31]
  ds_read_b64_tr_b16 v[48:49], v12 offset:28672
  s_waitcnt lgkmcnt(11)
  v_mfma_f32_16x16x32_bf16 v[28:31], v[52:55], v[104:107], v[28:31]
  ds_read_b64_tr_b16 v[50:51], v13 offset:30208
  v_mfma_f32_16x16x32_bf16 v[32:35], v[52:55], v[140:143], v[32:35]
  ds_read_b128 v[128:131], v3 offset:4096
  s_waitcnt lgkmcnt(11)
  v_mfma_f32_16x16x32_bf16 v[32:35], v[56:59], v[144:147], v[32:35]
  ds_read_b128 v[164:167], v3 offset:5120
  v_mfma_f32_16x16x32_bf16 v[28:31], v[56:59], v[108:111], v[28:31]
  ds_read_b64_tr_b16 v[52:53], v13 offset:32256
  s_waitcnt lgkmcnt(11)
  v_mfma_f32_16x16x32_bf16 v[28:31], v[60:63], v[112:115], v[28:31]
  ds_read_b64_tr_b16 v[54:55], v12 offset:33792
  v_mfma_f32_16x16x32_bf16 v[32:35], v[60:63], v[148:151], v[32:35]
  s_waitcnt lgkmcnt(0)
  s_barrier
  v_mfma_f32_16x16x32_bf16 v[32:35], v[64:67], v[152:155], v[32:35]
  ds_read_b64_tr_b16 v[56:57], v11 offset:0
  ds_read_b64_tr_b16 v[58:59], v11 offset:2048
  v_mfma_f32_16x16x32_bf16 v[28:31], v[64:67], v[116:119], v[28:31]
  ds_read_b64_tr_b16 v[60:61], v11 offset:4096
  v_mfma_f32_16x16x32_bf16 v[28:31], v[44:47], v[120:123], v[28:31]
  ds_read_b64_tr_b16 v[62:63], v11 offset:6144
  v_mfma_f32_16x16x32_bf16 v[32:35], v[44:47], v[156:159], v[32:35]
  ds_read_b64_tr_b16 v[64:65], v11 offset:8192
  v_mfma_f32_16x16x32_bf16 v[32:35], v[48:51], v[160:163], v[32:35]
  ds_read_b64_tr_b16 v[66:67], v11 offset:10240
  v_mfma_f32_16x16x32_bf16 v[28:31], v[48:51], v[124:127], v[28:31]
  ds_read_b64_tr_b16 v[44:45], v11 offset:14336
  v_mfma_f32_16x16x32_bf16 v[28:31], v[52:55], v[128:131], v[28:31]
  ds_read_b64_tr_b16 v[46:47], v11 offset:16384
  v_mfma_f32_16x16x32_bf16 v[32:35], v[52:55], v[164:167], v[32:35]
  ds_read_b64_tr_b16 v[48:49], v11 offset:18432
  s_waitcnt lgkmcnt(7)
  v_mfma_f32_16x16x32_bf16 v[36:39], v[56:59], v[96:99], 0
  ds_read_b64_tr_b16 v[50:51], v11 offset:20480
  v_mfma_f32_16x16x32_bf16 v[40:43], v[56:59], v[132:135], 0
  ds_read_b64_tr_b16 v[52:53], v11 offset:22528
  s_waitcnt lgkmcnt(7)
  v_mfma_f32_16x16x32_bf16 v[40:43], v[60:63], v[136:139], v[40:43]
  ds_read_b64_tr_b16 v[54:55], v11 offset:24576
  v_mfma_f32_16x16x32_bf16 v[36:39], v[60:63], v[100:103], v[36:39]
  ds_read_b64_tr_b16 v[56:57], v11 offset:12288
  s_waitcnt lgkmcnt(7)
  v_mfma_f32_16x16x32_bf16 v[36:39], v[64:67], v[104:107], v[36:39]
  ds_read_b64_tr_b16 v[58:59], v11 offset:26624
  v_mfma_f32_16x16x32_bf16 v[40:43], v[64:67], v[140:143], v[40:43]
  ds_read_b64_tr_b16 v[60:61], v12 offset:35840
  s_waitcnt lgkmcnt(7)
  v_mfma_f32_16x16x32_bf16 v[40:43], v[44:47], v[144:147], v[40:43]
  ds_read_b64_tr_b16 v[62:63], v13 offset:37376
  v_mfma_f32_16x16x32_bf16 v[36:39], v[44:47], v[108:111], v[36:39]
  ds_read_b64_tr_b16 v[64:65], v13 offset:39424
  v_cvt_pk_bf16_f32 v68, v28, v29
  v_cvt_pk_bf16_f32 v69, v30, v31
  v_cvt_pk_bf16_f32 v70, v32, v33
  v_cvt_pk_bf16_f32 v71, v34, v35
  v_readfirstlane_b32 s75, v7
  s_nop 0
  s_add_u32 s97, s97, s75
  s_add_u32 s3, s3, s75
  s_add_u32 s97, s97, 131072
  s_cmp_ge_u32 s97, s84
  s_cselect_b32 s75, 917504, 0
  s_sub_u32 s97, s97, s75
  buffer_store_dwordx4 v[68:71], v2, s[32:35], s97 offen sc1
  s_waitcnt lgkmcnt(7)
  v_mfma_f32_16x16x32_bf16 v[36:39], v[48:51], v[112:115], v[36:39]
  ds_read_b64_tr_b16 v[66:67], v12 offset:40960
  v_mfma_f32_16x16x32_bf16 v[40:43], v[48:51], v[148:151], v[40:43]
  s_waitcnt lgkmcnt(0)
  s_barrier
  v_mfma_f32_16x16x32_bf16 v[40:43], v[52:55], v[152:155], v[40:43]
  ds_read_b64_tr_b16 v[44:45], v10 offset:0
  ds_read_b64_tr_b16 v[46:47], v10 offset:2048
  v_mfma_f32_16x16x32_bf16 v[36:39], v[52:55], v[116:119], v[36:39]
  ds_read_b64_tr_b16 v[48:49], v10 offset:4096
  v_mfma_f32_16x16x32_bf16 v[36:39], v[56:59], v[120:123], v[36:39]
  ds_read_b64_tr_b16 v[50:51], v10 offset:6144
  v_mfma_f32_16x16x32_bf16 v[40:43], v[56:59], v[156:159], v[40:43]
  ds_read_b64_tr_b16 v[52:53], v10 offset:8192
  v_mfma_f32_16x16x32_bf16 v[40:43], v[60:63], v[160:163], v[40:43]
  ds_read_b64_tr_b16 v[54:55], v10 offset:10240
  v_mfma_f32_16x16x32_bf16 v[36:39], v[60:63], v[124:127], v[36:39]
  ds_read_b64_tr_b16 v[56:57], v10 offset:14336
  v_mfma_f32_16x16x32_bf16 v[36:39], v[64:67], v[128:131], v[36:39]
  ds_read_b64_tr_b16 v[58:59], v10 offset:16384
  v_mfma_f32_16x16x32_bf16 v[40:43], v[64:67], v[164:167], v[40:43]
  ds_read_b64_tr_b16 v[60:61], v10 offset:18432
  s_waitcnt lgkmcnt(7)
  v_mfma_f32_16x16x32_bf16 v[28:31], v[44:47], v[96:99], 0
  ds_read_b64_tr_b16 v[62:63], v10 offset:20480
  v_mfma_f32_16x16x32_bf16 v[32:35], v[44:47], v[132:135], 0
  ds_read_b64_tr_b16 v[64:65], v10 offset:22528
  s_waitcnt lgkmcnt(7)
  v_mfma_f32_16x16x32_bf16 v[32:35], v[48:51], v[136:139], v[32:35]
  ds_read_b64_tr_b16 v[66:67], v10 offset:24576
  v_mfma_f32_16x16x32_bf16 v[28:31], v[48:51], v[100:103], v[28:31]
  ds_read_b64_tr_b16 v[44:45], v10 offset:12288
  s_waitcnt lgkmcnt(7)
  v_mfma_f32_16x16x32_bf16 v[28:31], v[52:55], v[104:107], v[28:31]
  ds_read_b64_tr_b16 v[46:47], v10 offset:26624
  v_mfma_f32_16x16x32_bf16 v[32:35], v[52:55], v[140:143], v[32:35]
  ds_read_b64_tr_b16 v[48:49], v12 offset:43008
  s_waitcnt lgkmcnt(7)
  v_mfma_f32_16x16x32_bf16 v[32:35], v[56:59], v[144:147], v[32:35]
  ds_read_b64_tr_b16 v[50:51], v13 offset:44544
  v_mfma_f32_16x16x32_bf16 v[28:31], v[56:59], v[108:111], v[28:31]
  ds_read_b64_tr_b16 v[52:53], v13 offset:46592
  v_cvt_pk_bf16_f32 v72, v36, v37
  v_cvt_pk_bf16_f32 v73, v38, v39
  v_cvt_pk_bf16_f32 v74, v40, v41
  v_cvt_pk_bf16_f32 v75, v42, v43
  s_add_u32 s97, s97, 131072
  s_cmp_ge_u32 s97, s84
  s_cselect_b32 s75, 917504, 0
  s_sub_u32 s97, s97, s75
  buffer_store_dwordx4 v[72:75], v2, s[32:35], s97 offen sc1
  s_waitcnt lgkmcnt(7)
  v_mfma_f32_16x16x32_bf16 v[28:31], v[60:63], v[112:115], v[28:31]
  ds_read_b64_tr_b16 v[54:55], v12 offset:48128
  v_mfma_f32_16x16x32_bf16 v[32:35], v[60:63], v[148:151], v[32:35]
  s_waitcnt lgkmcnt(0)
  s_barrier
  v_mfma_f32_16x16x32_bf16 v[32:35], v[64:67], v[152:155], v[32:35]
  ds_read_b64_tr_b16 v[56:57], v10 offset:28672
  ds_read_b64_tr_b16 v[58:59], v10 offset:30720
  v_mfma_f32_16x16x32_bf16 v[28:31], v[64:67], v[116:119], v[28:31]
  ds_read_b64_tr_b16 v[60:61], v10 offset:32768
  v_mfma_f32_16x16x32_bf16 v[28:31], v[44:47], v[120:123], v[28:31]
  ds_read_b64_tr_b16 v[62:63], v10 offset:34816
  v_mfma_f32_16x16x32_bf16 v[32:35], v[44:47], v[156:159], v[32:35]
  ds_read_b64_tr_b16 v[64:65], v10 offset:36864
  v_mfma_f32_16x16x32_bf16 v[32:35], v[48:51], v[160:163], v[32:35]
  ds_read_b64_tr_b16 v[66:67], v10 offset:38912
  v_mfma_f32_16x16x32_bf16 v[28:31], v[48:51], v[124:127], v[28:31]
  ds_read_b64_tr_b16 v[44:45], v10 offset:43008
  v_mfma_f32_16x16x32_bf16 v[28:31], v[52:55], v[128:131], v[28:31]
  ds_read_b64_tr_b16 v[46:47], v10 offset:45056
  v_mfma_f32_16x16x32_bf16 v[32:35], v[52:55], v[164:167], v[32:35]
  ds_read_b64_tr_b16 v[48:49], v10 offset:47104
  s_waitcnt lgkmcnt(7)
  v_mfma_f32_16x16x32_bf16 v[36:39], v[56:59], v[96:99], 0
  ds_read_b64_tr_b16 v[50:51], v10 offset:49152
  v_mfma_f32_16x16x32_bf16 v[40:43], v[56:59], v[132:135], 0
  ds_read_b64_tr_b16 v[52:53], v10 offset:51200
  s_waitcnt lgkmcnt(7)
  v_mfma_f32_16x16x32_bf16 v[40:43], v[60:63], v[136:139], v[40:43]
  ds_read_b64_tr_b16 v[54:55], v10 offset:53248
  v_mfma_f32_16x16x32_bf16 v[36:39], v[60:63], v[100:103], v[36:39]
  ds_read_b64_tr_b16 v[56:57], v10 offset:40960
  s_waitcnt lgkmcnt(7)
  v_mfma_f32_16x16x32_bf16 v[36:39], v[64:67], v[104:107], v[36:39]
  ds_read_b64_tr_b16 v[58:59], v10 offset:55296
  v_mfma_f32_16x16x32_bf16 v[40:43], v[64:67], v[140:143], v[40:43]
  ds_read_b64_tr_b16 v[60:61], v12 offset:50176
  s_waitcnt lgkmcnt(7)
  v_mfma_f32_16x16x32_bf16 v[40:43], v[44:47], v[144:147], v[40:43]
  ds_read_b64_tr_b16 v[62:63], v13 offset:51712
  v_mfma_f32_16x16x32_bf16 v[36:39], v[44:47], v[108:111], v[36:39]
  ds_read_b64_tr_b16 v[64:65], v13 offset:53760
  v_cvt_pk_bf16_f32 v76, v28, v29
  v_cvt_pk_bf16_f32 v77, v30, v31
  v_cvt_pk_bf16_f32 v78, v32, v33
  v_cvt_pk_bf16_f32 v79, v34, v35
  s_add_u32 s97, s97, 131072
  s_cmp_ge_u32 s97, s84
  s_cselect_b32 s75, 917504, 0
  s_sub_u32 s97, s97, s75
  buffer_store_dwordx4 v[76:79], v2, s[32:35], s97 offen sc1
  s_waitcnt lgkmcnt(7)
  v_mfma_f32_16x16x32_bf16 v[36:39], v[48:51], v[112:115], v[36:39]
  ds_read_b64_tr_b16 v[66:67], v12 offset:55296
  v_mfma_f32_16x16x32_bf16 v[40:43], v[48:51], v[148:151], v[40:43]
  s_waitcnt vmcnt(2) lgkmcnt(0)
  s_barrier
  v_mfma_f32_16x16x32_bf16 v[40:43], v[52:55], v[152:155], v[40:43]
  ds_read_b64_tr_b16 v[44:45], v12 offset:0
  ds_read_b64_tr_b16 v[46:47], v12 offset:2048
  v_mfma_f32_16x16x32_bf16 v[36:39], v[52:55], v[116:119], v[36:39]
  ds_read_b64_tr_b16 v[48:49], v12 offset:4096
  v_mfma_f32_16x16x32_bf16 v[36:39], v[56:59], v[120:123], v[36:39]
  ds_read_b64_tr_b16 v[50:51], v12 offset:6144
  v_mfma_f32_16x16x32_bf16 v[40:43], v[56:59], v[156:159], v[40:43]
  ds_read_b64_tr_b16 v[52:53], v12 offset:8192
  v_mfma_f32_16x16x32_bf16 v[40:43], v[60:63], v[160:163], v[40:43]
  ds_read_b64_tr_b16 v[54:55], v12 offset:10240
  v_mfma_f32_16x16x32_bf16 v[36:39], v[60:63], v[124:127], v[36:39]
  ds_read_b64_tr_b16 v[56:57], v12 offset:14336
  v_mfma_f32_16x16x32_bf16 v[36:39], v[64:67], v[128:131], v[36:39]
  ds_read_b64_tr_b16 v[58:59], v12 offset:16384
  v_mfma_f32_16x16x32_bf16 v[40:43], v[64:67], v[164:167], v[40:43]
  ds_read_b64_tr_b16 v[60:61], v12 offset:18432
  s_waitcnt lgkmcnt(7)
  v_mfma_f32_16x16x32_bf16 v[28:31], v[44:47], v[96:99], 0
  ds_read_b64_tr_b16 v[62:63], v12 offset:20480
  v_mfma_f32_16x16x32_bf16 v[32:35], v[44:47], v[132:135], 0
  ds_read_b64_tr_b16 v[64:65], v12 offset:22528
  s_waitcnt lgkmcnt(7)
  v_mfma_f32_16x16x32_bf16 v[32:35], v[48:51], v[136:139], v[32:35]
  ds_read_b64_tr_b16 v[66:67], v12 offset:24576
  v_mfma_f32_16x16x32_bf16 v[28:31], v[48:51], v[100:103], v[28:31]
  ds_read_b64_tr_b16 v[44:45], v12 offset:12288
  s_waitcnt lgkmcnt(7)
  v_mfma_f32_16x16x32_bf16 v[28:31], v[52:55], v[104:107], v[28:31]
  ds_read_b64_tr_b16 v[46:47], v12 offset:26624
  v_mfma_f32_16x16x32_bf16 v[32:35], v[52:55], v[140:143], v[32:35]
  ds_read_b64_tr_b16 v[48:49], v12 offset:28672
  s_waitcnt lgkmcnt(7)
  v_mfma_f32_16x16x32_bf16 v[32:35], v[56:59], v[144:147], v[32:35]
  ds_read_b64_tr_b16 v[50:51], v13 offset:30208
  v_mfma_f32_16x16x32_bf16 v[28:31], v[56:59], v[108:111], v[28:31]
  ds_read_b64_tr_b16 v[52:53], v13 offset:32256
  v_cvt_pk_bf16_f32 v80, v36, v37
  v_cvt_pk_bf16_f32 v81, v38, v39
  v_cvt_pk_bf16_f32 v82, v40, v41
  v_cvt_pk_bf16_f32 v83, v42, v43
  s_add_u32 s97, s97, 131072
  s_cmp_ge_u32 s97, s84
  s_cselect_b32 s75, 917504, 0
  s_sub_u32 s97, s97, s75
  buffer_store_dwordx4 v[80:83], v2, s[32:35], s97 offen sc1
  s_waitcnt lgkmcnt(7)
  v_mfma_f32_16x16x32_bf16 v[28:31], v[60:63], v[112:115], v[28:31]
  ds_read_b64_tr_b16 v[54:55], v12 offset:33792
  v_mfma_f32_16x16x32_bf16 v[32:35], v[60:63], v[148:151], v[32:35]
  s_waitcnt vmcnt(1) lgkmcnt(0)
  s_barrier
  v_mfma_f32_16x16x32_bf16 v[32:35], v[64:67], v[152:155], v[32:35]
  ds_read_b64_tr_b16 v[56:57], v11 offset:0
  ds_read_b64_tr_b16 v[58:59], v11 offset:2048
  v_mfma_f32_16x16x32_bf16 v[28:31], v[64:67], v[116:119], v[28:31]
  ds_read_b64_tr_b16 v[60:61], v11 offset:4096
  v_mfma_f32_16x16x32_bf16 v[28:31], v[44:47], v[120:123], v[28:31]
  ds_read_b64_tr_b16 v[62:63], v11 offset:6144
  v_mfma_f32_16x16x32_bf16 v[32:35], v[44:47], v[156:159], v[32:35]
  ds_read_b64_tr_b16 v[64:65], v11 offset:8192
  v_mfma_f32_16x16x32_bf16 v[32:35], v[48:51], v[160:163], v[32:35]
  ds_read_b64_tr_b16 v[66:67], v11 offset:10240
  v_mfma_f32_16x16x32_bf16 v[28:31], v[48:51], v[124:127], v[28:31]
  ds_read_b64_tr_b16 v[44:45], v11 offset:14336
  v_mfma_f32_16x16x32_bf16 v[28:31], v[52:55], v[128:131], v[28:31]
  ds_read_b64_tr_b16 v[46:47], v11 offset:16384
  v_mfma_f32_16x16x32_bf16 v[32:35], v[52:55], v[164:167], v[32:35]
  ds_read_b64_tr_b16 v[48:49], v11 offset:18432
  s_waitcnt lgkmcnt(7)
  v_mfma_f32_16x16x32_bf16 v[36:39], v[56:59], v[96:99], 0
  ds_read_b64_tr_b16 v[50:51], v11 offset:20480
  v_mfma_f32_16x16x32_bf16 v[40:43], v[56:59], v[132:135], 0
  ds_read_b64_tr_b16 v[52:53], v11 offset:22528
  s_waitcnt lgkmcnt(7)
  v_mfma_f32_16x16x32_bf16 v[40:43], v[60:63], v[136:139], v[40:43]
  ds_read_b64_tr_b16 v[54:55], v11 offset:24576
  v_mfma_f32_16x16x32_bf16 v[36:39], v[60:63], v[100:103], v[36:39]
  ds_read_b64_tr_b16 v[56:57], v11 offset:12288
  s_waitcnt lgkmcnt(7)
  v_mfma_f32_16x16x32_bf16 v[36:39], v[64:67], v[104:107], v[36:39]
  ds_read_b64_tr_b16 v[58:59], v11 offset:26624
  v_mfma_f32_16x16x32_bf16 v[40:43], v[64:67], v[140:143], v[40:43]
  ds_read_b64_tr_b16 v[60:61], v12 offset:57344
  s_waitcnt lgkmcnt(7)
  v_mfma_f32_16x16x32_bf16 v[40:43], v[44:47], v[144:147], v[40:43]
  ds_read_b64_tr_b16 v[62:63], v13 offset:58880
  v_mfma_f32_16x16x32_bf16 v[36:39], v[44:47], v[108:111], v[36:39]
  ds_read_b64_tr_b16 v[64:65], v13 offset:60928
  v_cvt_pk_bf16_f32 v84, v28, v29
  v_cvt_pk_bf16_f32 v85, v30, v31
  v_cvt_pk_bf16_f32 v86, v32, v33
  v_cvt_pk_bf16_f32 v87, v34, v35
  s_add_u32 s97, s97, 131072
  s_cmp_ge_u32 s97, s84
  s_cselect_b32 s75, 917504, 0
  s_sub_u32 s97, s97, s75
  buffer_store_dwordx4 v[84:87], v2, s[32:35], s97 offen sc1
  s_waitcnt lgkmcnt(7)
  v_mfma_f32_16x16x32_bf16 v[36:39], v[48:51], v[112:115], v[36:39]
  ds_read_b64_tr_b16 v[66:67], v12 offset:62464
  v_mfma_f32_16x16x32_bf16 v[40:43], v[48:51], v[148:151], v[40:43]
  s_waitcnt lgkmcnt(6)
  v_mfma_f32_16x16x32_bf16 v[40:43], v[52:55], v[152:155], v[40:43]
  v_mfma_f32_16x16x32_bf16 v[36:39], v[52:55], v[116:119], v[36:39]
  s_waitcnt lgkmcnt(4)
  v_mfma_f32_16x16x32_bf16 v[36:39], v[56:59], v[120:123], v[36:39]
  v_mfma_f32_16x16x32_bf16 v[40:43], v[56:59], v[156:159], v[40:43]
  s_waitcnt lgkmcnt(2)
  v_mfma_f32_16x16x32_bf16 v[40:43], v[60:63], v[160:163], v[40:43]
  v_mfma_f32_16x16x32_bf16 v[36:39], v[60:63], v[124:127], v[36:39]
  s_waitcnt lgkmcnt(0)
  v_mfma_f32_16x16x32_bf16 v[36:39], v[64:67], v[128:131], v[36:39]
  v_mfma_f32_16x16x32_bf16 v[40:43], v[64:67], v[164:167], v[40:43]
  v_and_b32 v4, 15, v1
  v_bfe_u32 v5, v1, 1, 2
  s_lshr_b32 s76, s93, 1
  v_xor_b32 v5, s76, v5
  v_lshlrev_b32 v5, 5, v5
  v_lshl_add_u32 v5, v4, 7, v5
  v_lshrrev_b32 v6, 4, v1
  v_lshlrev_b32 v6, 3, v6
  v_cvt_pk_bf16_f32 v88, v36, v37
  v_cvt_pk_bf16_f32 v89, v38, v39
  v_cvt_pk_bf16_f32 v90, v40, v41
  v_cvt_pk_bf16_f32 v91, v42, v43
  s_add_u32 s97, s97, 131072
  s_cmp_ge_u32 s97, s84
  s_cselect_b32 s75, 917504, 0
  s_sub_u32 s97, s97, s75
  buffer_store_dwordx4 v[88:91], v2, s[32:35], s97 offen sc1
  s_cmp_eq_u32 s65, 7
  s_cbranch_scc1 L_s721
  s_lshl_b32 s83, s65, 7
  s_lshl_b32 s75, s72, 12
  s_add_u32 s75, s75, 153600
  v_add3_u32 v5, v5, v6, s75
  s_lshl_b32 s76, s76, 5
  s_add_u32 s83, s83, s76
  s_movk_i32 s55, 0x3f80
  s_add_u32 s76, s76, 161792
  v_add_u32 v6, s76, v6
  ds_read_b64 v[14:15], v5
  ds_read_b64 v[16:17], v5 offset:2048
  ds_read_b64 v[18:19], v6
  s_lshl_b32 s75, s72, 6
  s_add_u32 s75, s75, s74
  v_lshl_add_u32 v4, v4, 1, s75
  v_bfe_u32 v5, v1, 4, 1
  v_lshl_add_u32 v4, v5, 5, v4
  v_mul_u32_u24 v4, 896, v4
  v_lshrrev_b32 v6, 5, v1
  v_lshl_add_u32 v8, v6, 4, v4
  v_mov_b32 v9, 0x3f800000
  s_waitcnt lgkmcnt(0)
  v_lshlrev_b32 v4, 16, v18
  v_and_b32 v5, 0xffff0000, v18
  v_dot2_f32_bf16 v28, v14, s55, v4
  v_dot2_f32_bf16 v29, v14, v9, v5
  v_dot2_f32_bf16 v32, v16, s55, v4
  v_dot2_f32_bf16 v33, v16, v9, v5
  v_lshlrev_b32 v4, 16, v19
  v_and_b32 v5, 0xffff0000, v19
  v_dot2_f32_bf16 v30, v15, s55, v4
  v_dot2_f32_bf16 v31, v15, v9, v5
  v_dot2_f32_bf16 v34, v17, s55, v4
  v_dot2_f32_bf16 v35, v17, v9, v5
  v_mov_b32 v4, 161920
  v_mov_b32 v5, 1
  s_add_u32 s11, s65, 4
  s_sub_u32 s10, s11, 7
  s_min_u32 s11, s11, s10
  s_lshl_b32 s11, s11, 10
  s_add_u32 s11, s11, s3
  s_cmp_eq_u32 s65, 7
  s_cselect_b32 s10, 64, 8
  s_add_u32 s13, s65, 5
  s_sub_u32 s12, s13, 7
  s_min_u32 s13, s13, s12
  s_lshl_b32 s13, s13, 10
  s_add_u32 s13, s13, s3
  s_cmp_eq_u32 s65, 7
  s_cselect_b32 s12, 64, 16
  s_add_u32 s15, s65, 6
  s_sub_u32 s14, s15, 7
  s_min_u32 s15, s15, s14
  s_lshl_b32 s15, s15, 10
  s_add_u32 s15, s15, s3
  s_cmp_eq_u32 s65, 7
  s_cselect_b32 s14, 64, 32
  s_mov_b64 exec, 1
  s_waitcnt vmcnt(0)
  ds_add_rtn_u32 v5, v4, v5
  s_waitcnt lgkmcnt(0)
  v_cmp_eq_u32 vcc, 7, v5
  s_mov_b64 exec, -1
  s_nop 0
  s_cbranch_vccz L_nf22
  s_atomic_add s14, s[32:33], s15
  s_atomic_add s12, s[32:33], s13
  s_atomic_add s10, s[32:33], s11
L_nf22:
L_ns20:
  v_mov_b32 v6, 161932
  s_mov_b32 s96, 0
L_lw23:
  ds_read_b32 v7, v6
  s_add_u32 s96, s96, 1
  s_cmp_gt_u32 s96, 3200000
  s_waitcnt lgkmcnt(0)
  v_cmp_gt_u32 vcc, 2, v7
  s_cbranch_scc1 L_lo24
  s_nop 0
  s_cbranch_vccnz L_lw23
L_lo24:
  ds_read_b64_tr_b16 v[44:45], v10 offset:0
  ds_read_b64_tr_b16 v[46:47], v10 offset:2048
  ds_read_b64_tr_b16 v[48:49], v10 offset:4096
  ds_read_b64_tr_b16 v[50:51], v10 offset:6144
  ds_read_b64_tr_b16 v[52:53], v10 offset:8192
  ds_read_b64_tr_b16 v[54:55], v10 offset:10240
  s_waitcnt lgkmcnt(4)
  v_mfma_f32_16x16x32_bf16 v[28:31], v[44:47], v[96:99], v[28:31]
  v_mfma_f32_16x16x32_bf16 v[32:35], v[44:47], v[132:135], v[32:35]
  ds_read_b64_tr_b16 v[56:57], v10 offset:14336
  ds_read_b64_tr_b16 v[58:59], v10 offset:16384
  s_waitcnt lgkmcnt(4)
  v_mfma_f32_16x16x32_bf16 v[32:35], v[48:51], v[136:139], v[32:35]
  ds_read_b64_tr_b16 v[60:61], v10 offset:18432
  ds_read_b64_tr_b16 v[62:63], v10 offset:20480
  v_mfma_f32_16x16x32_bf16 v[28:31], v[48:51], v[100:103], v[28:31]
  ds_read_b64_tr_b16 v[64:65], v10 offset:22528
  ds_read_b64_tr_b16 v[66:67], v10 offset:24576
  s_waitcnt lgkmcnt(6)
  v_mfma_f32_16x16x32_bf16 v[28:31], v[52:55], v[104:107], v[28:31]
  ds_read_b64_tr_b16 v[44:45], v10 offset:12288
  ds_read_b64_tr_b16 v[46:47], v10 offset:26624
  v_mfma_f32_16x16x32_bf16 v[32:35], v[52:55], v[140:143], v[32:35]
  ds_read_b64_tr_b16 v[48:49], v12 offset:35840
  s_waitcnt lgkmcnt(7)
  v_mfma_f32_16x16x32_bf16 v[32:35], v[56:59], v[144:147], v[32:35]
  ds_read_b64_tr_b16 v[50:51], v13 offset:37376
  v_mfma_f32_16x16x32_bf16 v[28:31], v[56:59], v[108:111], v[28:31]
  ds_read_b64_tr_b16 v[52:53], v13 offset:39424
  s_waitcnt lgkmcnt(7)
  v_mfma_f32_16x16x32_bf16 v[28:31], v[60:63], v[112:115], v[28:31]
  ds_read_b64_tr_b16 v[54:55], v12 offset:40960
  v_mfma_f32_16x16x32_bf16 v[32:35], v[60:63], v[148:151], v[32:35]
  s_waitcnt lgkmcnt(6)
  v_mfma_f32_16x16x32_bf16 v[32:35], v[64:67], v[152:155], v[32:35]
  v_mfma_f32_16x16x32_bf16 v[28:31], v[64:67], v[116:119], v[28:31]
  s_waitcnt lgkmcnt(4)
  v_mfma_f32_16x16x32_bf16 v[28:31], v[44:47], v[120:123], v[28:31]
  v_mfma_f32_16x16x32_bf16 v[32:35], v[44:47], v[156:159], v[32:35]
  s_waitcnt lgkmcnt(2)
  v_mfma_f32_16x16x32_bf16 v[32:35], v[48:51], v[160:163], v[32:35]
  v_mfma_f32_16x16x32_bf16 v[28:31], v[48:51], v[124:127], v[28:31]
  s_waitcnt lgkmcnt(0)
  v_mfma_f32_16x16x32_bf16 v[28:31], v[52:55], v[128:131], v[28:31]
  v_mfma_f32_16x16x32_bf16 v[32:35], v[52:55], v[164:167], v[32:35]
  s_cmp_lg_u32 s65, 7
  s_cbranch_scc1 L_own25
  s_nop 5
  v_cvt_pk_bf16_f32 v92, v28, v29
  v_cvt_pk_bf16_f32 v93, v30, v31
  v_cvt_pk_bf16_f32 v94, v32, v33
  v_cvt_pk_bf16_f32 v95, v34, v35
  s_add_u32 s97, s97, 131072
  s_cmp_ge_u32 s97, s84
  s_cselect_b32 s75, 917504, 0
  s_sub_u32 s97, s97, s75
  buffer_store_dwordx4 v[92:95], v2, s[32:35], s97 offen sc1
  v_mov_b32 v4, 161928
  v_mov_b32 v5, 1
  s_add_u32 s11, s65, 4
  s_sub_u32 s10, s11, 7
  s_min_u32 s11, s11, s10
  s_lshl_b32 s11, s11, 10
  s_add_u32 s11, s11, s3
  s_cmp_eq_u32 s65, 7
  s_cselect_b32 s10, 64, 8
  s_add_u32 s13, s65, 5
  s_sub_u32 s12, s13, 7
  s_min_u32 s13, s13, s12
  s_lshl_b32 s13, s13, 10
  s_add_u32 s13, s13, s3
  s_cmp_eq_u32 s65, 7
  s_cselect_b32 s12, 64, 16
  s_add_u32 s15, s65, 6
  s_sub_u32 s14, s15, 7
  s_min_u32 s15, s15, s14
  s_lshl_b32 s15, s15, 10
  s_add_u32 s15, s15, s3
  s_cmp_eq_u32 s65, 7
  s_cselect_b32 s14, 64, 32
  s_mov_b64 exec, 1
  s_waitcnt vmcnt(1)
  ds_add_rtn_u32 v5, v4, v5
  s_waitcnt lgkmcnt(0)
  v_cmp_eq_u32 vcc, 7, v5
  s_mov_b64 exec, -1
  s_nop 0
  s_cbranch_vccz L_nf27
  s_atomic_add s14, s[32:33], s15
  s_atomic_add s12, s[32:33], s13
  s_atomic_add s10, s[32:33], s11
L_nf27:
  v_mov_b32 v4, 161920
  v_mov_b32 v5, 1
  s_add_u32 s17, s65, 0
  s_sub_u32 s16, s17, 7
  s_min_u32 s17, s17, s16
  s_lshl_b32 s17, s17, 10
  s_add_u32 s17, s17, s3
  s_cmp_eq_u32 s65, 7
  s_cselect_b32 s16, 64, 64
  s_mov_b64 exec, 1
  s_waitcnt vmcnt(0)
  ds_add_rtn_u32 v5, v4, v5
  s_waitcnt lgkmcnt(0)
  v_cmp_eq_u32 vcc, 7, v5
  s_mov_b64 exec, -1
  s_nop 0
  s_cbranch_vccz L_nf28
  s_atomic_add s16, s[32:33], s17
L_nf28:
  s_branch L_done26
L_own25:
  s_nop 0
  v_add_u32 v4, s81, v2
  v_add_u32 v5, 65536, v4
  s_nop 1
  v_mov_b32 v6, 161936
  s_mov_b32 s96, 0
L_lw29:
  ds_read_b32 v7, v6
  s_add_u32 s96, s96, 1
  s_cmp_gt_u32 s96, 3200000
  s_waitcnt lgkmcnt(0)
  v_cmp_gt_u32 vcc, 1, v7
  s_cbranch_scc1 L_lo30
  s_nop 0
  s_cbranch_vccnz L_lw29
L_lo30:
  ds_read_b128 v[68:71], v5 offset:28672
  ds_read_b128 v[72:75], v5 offset:36864
  ds_read_b128 v[76:79], v5 offset:45056
  s_waitcnt lgkmcnt(2)
  v_dot2_f32_bf16 v28, v68, s55, v28
  v_dot2_f32_bf16 v29, v68, v9, v29
  v_dot2_f32_bf16 v30, v69, s55, v30
  v_dot2_f32_bf16 v31, v69, v9, v31
  v_dot2_f32_bf16 v32, v70, s55, v32
  v_dot2_f32_bf16 v33, v70, v9, v33
  v_dot2_f32_bf16 v34, v71, s55, v34
  v_dot2_f32_bf16 v35, v71, v9, v35
  s_waitcnt lgkmcnt(1)
  v_dot2_f32_bf16 v28, v72, s55, v28
  v_dot2_f32_bf16 v29, v72, v9, v29
  v_dot2_f32_bf16 v30, v73, s55, v30
  v_dot2_f32_bf16 v31, v73, v9, v31
  v_dot2_f32_bf16 v32, v74, s55, v32
  v_dot2_f32_bf16 v33, v74, v9, v33
  v_dot2_f32_bf16 v34, v75, s55, v34
  v_dot2_f32_bf16 v35, v75, v9, v35
  s_waitcnt lgkmcnt(0)
  v_dot2_f32_bf16 v28, v76, s55, v28
  v_dot2_f32_bf16 v29, v76, v9, v29
  v_dot2_f32_bf16 v30, v77, s55, v30
  v_dot2_f32_bf16 v31, v77, v9, v31
  v_dot2_f32_bf16 v32, v78, s55, v32
  v_dot2_f32_bf16 v33, v78, v9, v33
  v_dot2_f32_bf16 v34, v79, s55, v34
  v_dot2_f32_bf16 v35, v79, v9, v35
  s_barrier
  ds_read_b128 v[80:83], v4 offset:0
  ds_read_b128 v[84:87], v4 offset:8192
  ds_read_b128 v[88:91], v4 offset:16384
  ds_read_b128 v[92:95], v4 offset:24576
  s_waitcnt lgkmcnt(3)
  v_dot2_f32_bf16 v28, v80, s55, v28
  v_dot2_f32_bf16 v29, v80, v9, v29
  v_dot2_f32_bf16 v30, v81, s55, v30
  v_dot2_f32_bf16 v31, v81, v9, v31
  v_dot2_f32_bf16 v32, v82, s55, v32
  v_dot2_f32_bf16 v33, v82, v9, v33
  v_dot2_f32_bf16 v34, v83, s55, v34
  v_dot2_f32_bf16 v35, v83, v9, v35
  s_waitcnt lgkmcnt(2)
  v_dot2_f32_bf16 v28, v84, s55, v28
  v_dot2_f32_bf16 v29, v84, v9, v29
  v_dot2_f32_bf16 v30, v85, s55, v30
  v_dot2_f32_bf16 v31, v85, v9, v31
  v_dot2_f32_bf16 v32, v86, s55, v32
  v_dot2_f32_bf16 v33, v86, v9, v33
  v_dot2_f32_bf16 v34, v87, s55, v34
  v_dot2_f32_bf16 v35, v87, v9, v35
  s_waitcnt lgkmcnt(1)
  v_dot2_f32_bf16 v28, v88, s55, v28
  v_dot2_f32_bf16 v29, v88, v9, v29
  v_dot2_f32_bf16 v30, v89, s55, v30
  v_dot2_f32_bf16 v31, v89, v9, v31
  v_dot2_f32_bf16 v32, v90, s55, v32
  v_dot2_f32_bf16 v33, v90, v9, v33
  v_dot2_f32_bf16 v34, v91, s55, v34
  v_dot2_f32_bf16 v35, v91, v9, v35
  s_waitcnt lgkmcnt(0)
  v_dot2_f32_bf16 v28, v92, s55, v28
  v_dot2_f32_bf16 v29, v92, v9, v29
  v_dot2_f32_bf16 v30, v93, s55, v30
  v_dot2_f32_bf16 v31, v93, v9, v31
  v_dot2_f32_bf16 v32, v94, s55, v32
  v_dot2_f32_bf16 v33, v94, v9, v33
  v_dot2_f32_bf16 v34, v95, s55, v34
  v_dot2_f32_bf16 v35, v95, v9, v35
  s_nop 1
  v_cvt_pk_bf16_f32 v20, v28, v29
  v_cvt_pk_bf16_f32 v21, v30, v31
  v_cvt_pk_bf16_f32 v22, v32, v33
  v_cvt_pk_bf16_f32 v23, v34, v35
  s_nop 1
  v_permlane16_swap_b32 v20, v22
  v_permlane16_swap_b32 v21, v23
  s_nop 0
  buffer_store_dwordx4 v[20:23], v8, s[36:39], s83 offen
L_done26:
  s_endpgm
L_L:
  s_setprio 3
  v_and_b32 v1, 63, v0
  v_lshlrev_b32 v2, 4, v1
  s_and_b32 s71, s68, 3
  s_and_b32 s75, s2, 1
  s_lshl_b32 s75, s75, 2
  s_and_b32 s77, s3, 3
  s_add_u32 s69, s75, s77
  s_lshr_b32 s75, s3, 2
  s_and_b32 s64, s75, 3
  s_mul_i32 s64, s64, 2
  s_mul_i32 s65, s70, 1
  s_and_b32 s65, s65, 4
  s_xor_b32 s65, s65, s69
  s_or_b32 s78, s2, s68
  s_cmp_lg_u32 s78, 0
  s_cbranch_scc1 L_nolead0
  s_memrealtime s[94:95]
L_nolead0:
  v_add_u32 v4, 0, v1
  v_mul_u32_u24 v6, 2979, v4
  v_lshrrev_b32 v6, 16, v6
  v_mul_u32_u24 v7, 22, v6
  v_sub_u32 v4, v4, v7
  v_min_u32 v4, 20, v4
  v_mul_u32_u24 v7, 37, v4
  v_lshrrev_b32 v7, 8, v7
  v_mul_u32_u24 v7, 784, v7
  v_lshl_add_u32 v4, v4, 4, v7
  v_mul_u32_u24 v6, 2688, v6
  v_add_u32 v12, v4, v6
  v_add_u32 v4, 64, v1
  v_mul_u32_u24 v6, 2979, v4
  v_lshrrev_b32 v6, 16, v6
  v_mul_u32_u24 v7, 22, v6
  v_sub_u32 v4, v4, v7
  v_min_u32 v4, 20, v4
  v_mul_u32_u24 v7, 37, v4
  v_lshrrev_b32 v7, 8, v7
  v_mul_u32_u24 v7, 784, v7
  v_lshl_add_u32 v4, v4, 4, v7
  v_mul_u32_u24 v6, 2688, v6
  v_add_u32 v13, v4, v6
  s_and_b32 s77, s71, 1
  s_lshl_b32 s77, s77, 3
  s_lshr_b32 s76, s71, 1
  s_lshl_b32 s76, s76, 2
  s_add_u32 s77, s77, s76
  s_lshl_b32 s76, s70, 4
  s_add_u32 s77, s77, s76
  s_mul_i32 s77, s77, 2688
  s_mul_i32 s76, s69, 112
  s_add_u32 s85, s77, s76
  s_and_b32 s82, s70, 31
  s_lshl_b32 s76, s82, 2
  s_add_u32 s72, s76, s71
  s_mul_i32 s76, s72, 1
  v_min_u32 v5, 3, v1
  v_lshrrev_b32 v6, 2, v5
  v_add_u32 v6, s76, v6
  v_and_b32 v5, 3, v5
  v_mul_u32_u24 v6, 3584, v6
  v_lshl_add_u32 v28, v5, 7, v6
  s_mul_i32 s79, s69, 448
  s_and_b32 s73, s79, 0xffffff80
  v_mov_b32 v15, 0
  s_waitcnt lgkmcnt(0)
  s_mov_b32 s40, s6
  s_and_b32 s41, s7, 0xffff
  s_mov_b32 s42, 1204224
  s_mov_b32 s43, 0x20000
  s_mov_b32 s36, s12
  s_and_b32 s37, s13, 0xffff
  s_mov_b32 s38, 1605632
  s_mov_b32 s39, 0x20000
  buffer_load_dwordx4 v[16:19], v12, s[40:43], s85 offen
  s_mov_b64 exec, 0xffffff
  buffer_load_dwordx4 v[20:23], v13, s[40:43], s85 offen
  s_mov_b64 exec, -1
  s_mov_b32 s44, s24
  s_and_b32 s45, s25, 0xffff
  s_mov_b32 s46, 256
  s_mov_b32 s47, 0x20000
  s_cmp_lg_u32 s78, 0
  s_cbranch_scc1 L_nolead1
  s_and_b32 s94, s94, -16
  s_or_b32 s62, s94, 16
  s_atomic_swap s62, s[44:45], 0
  s_atomic_swap s62, s[44:45], 64
L_nolead1:
  s_mov_b32 s32, s26
  s_and_b32 s33, s27, 0xffff
  s_mov_b32 s34, 268435456
  s_mov_b32 s35, 0x20000
  s_mov_b32 s48, s16
  s_and_b32 s49, s17, 0xffff
  s_mov_b32 s50, 1605632
  s_mov_b32 s51, 0x20000
  s_mov_b32 s52, s8
  s_and_b32 s53, s9, 0xffff
  s_mov_b32 s54, 401408
  s_mov_b32 s55, 0x20000
  s_mov_b32 s28, s4
  s_and_b32 s29, s5, 0xffff
  s_mov_b32 s30, 1835008
  s_mov_b32 s31, 0x20000
  s_mov_b32 s56, s18
  s_and_b32 s57, s19, 0xffff
  s_mov_b32 s58, 896
  s_mov_b32 s59, 0x20000
  v_mul_u32_u24 v4, 2341, v1
  v_xor_b32 v5, 32, v2
  v_and_b32 v6, 32, v1
  v_xor_b32 v6, v6, v2
  s_movk_i32 s76, 3136
  v_add_u32 v7, 0, v4
  v_lshrrev_b32 v7, 16, v7
  v_mad_u32_u24 v32, v7, s76, v2
  v_add_u32 v7, 149824, v4
  v_lshrrev_b32 v7, 16, v7
  v_mad_u32_u24 v33, v7, s76, v2
  v_add_u32 v7, 299648, v4
  v_lshrrev_b32 v7, 16, v7
  v_mad_u32_u24 v34, v7, s76, v2
  v_add_u32 v7, 449472, v4
  v_lshrrev_b32 v7, 16, v7
  v_mad_u32_u24 v35, v7, s76, v6
  v_add_u32 v7, 599296, v4
  v_lshrrev_b32 v7, 16, v7
  v_mad_u32_u24 v36, v7, s76, v5
  v_add_u32 v7, 749120, v4
  v_lshrrev_b32 v7, 16, v7
  v_mad_u32_u24 v37, v7, s76, v5
  v_add_u32 v7, 898944, v4
  v_lshrrev_b32 v7, 16, v7
  v_mad_u32_u24 v38, v7, s76, v5
  s_mul_i32 s76, s71, 57344
  s_add_u32 s79, s79, s76
  s_mul_i32 s83, s71, 7168
  s_setprio 0
  s_mul_i32 s93, s64, 229376
  s_add_u32 m0, s83, 65536
  s_add_u32 s75, s79, s93
  buffer_load_dwordx4 v32, s[36:39], s75 offen offset:0 lds
  buffer_load_dwordx4 v33, s[36:39], s75 offen offset:1024 lds
  buffer_load_dwordx4 v34, s[36:39], s75 offen offset:2048 lds
  buffer_load_dwordx4 v35, s[36:39], s75 offen offset:3072 lds
  s_add_u32 m0, s83, 69632
  s_add_u32 s75, s75, 4096
  buffer_load_dwordx4 v36, s[36:39], s75 offen offset:0 lds
  buffer_load_dwordx4 v37, s[36:39], s75 offen offset:1024 lds
  buffer_load_dwordx4 v38, s[36:39], s75 offen offset:2048 lds
  s_add_u32 s86, s65, 1
  s_cmp_ge_u32 s86, 7
  s_cselect_b32 s75, 7, 0
  s_sub_u32 s86, s86, s75
  s_add_u32 s87, s86, 1
  s_cmp_ge_u32 s87, 7
  s_cselect_b32 s75, 7, 0
  s_sub_u32 s87, s87, s75
  s_add_u32 s88, s87, 1
  s_cmp_ge_u32 s88, 7
  s_cselect_b32 s75, 7, 0
  s_sub_u32 s88, s88, s75
  s_add_u32 s89, s88, 1
  s_cmp_ge_u32 s89, 7
  s_cselect_b32 s75, 7, 0
  s_sub_u32 s89, s89, s75
  s_add_u32 s90, s89, 1
  s_cmp_ge_u32 s90, 7
  s_cselect_b32 s75, 7, 0
  s_sub_u32 s90, s90, s75
  s_add_u32 s91, s90, 1
  s_cmp_ge_u32 s91, 7
  s_cselect_b32 s75, 7, 0
  s_sub_u32 s91, s91, s75
  s_add_u32 s92, s91, 1
  s_cmp_ge_u32 s92, 7
  s_cselect_b32 s75, 7, 0
  s_sub_u32 s92, s92, s75
  v_lshrrev_b32 v4, 3, v1
  v_lshrrev_b32 v5, 4, v1
  v_lshlrev_b32 v5, 1, v5
  v_and_b32 v6, 7, v1
  v_xor_b32 v5, v5, v6
  v_mul_u32_u24 v4, 896, v4
  v_lshl_add_u32 v10, v5, 4, v4
  v_add_u32 v29, v10, v4
  s_mul_i32 s81, s69, 200704
  s_mul_i32 s75, s71, 7168
  s_add_u32 s81, s81, s75
  s_lshl_b32 s27, s71, 10
  s_mul_i32 s80, s69, 157696
  s_add_u32 s80, s80, 35651584
  s_mul_i32 s97, s71, 5632
  s_add_u32 s80, s80, s97
  s_mul_i32 s77, s69, 50176
  s_lshl_b32 s75, s71, 1
  s_add_u32 s76, s75, 1
  s_min_u32 s76, s76, 6
  s_lshl_b32 s20, s75, 10
  s_lshl_b32 s21, s76, 10
  s_mul_i32 s22, s75, 7168
  s_mul_i32 s23, s76, 7168
  s_add_u32 s22, s22, s77
  s_add_u32 s23, s23, s77
  s_cmp_eq_u32 s71, 3
  s_cselect_b64 s[18:19], 0xff, -1
  s_mul_i32 s76, s69, 157696
  s_add_u32 s76, s76, 35651584
  s_lshl_b32 s75, s70, 2
  s_add_u32 s75, s75, s71
  s_mul_i32 s75, s75, 1408
  s_add_u32 s75, s75, s76
  s_cmp_ge_u32 s70, 28
  s_cselect_b32 s75, 2146435072, s75
  s_sub_u32 s77, 0, s32
  s_and_b32 s77, s77, 0xfffff
  s_lshl_b32 s25, s70, 20
  s_add_u32 s25, s25, s77
  s_add_u32 s25, s25, 917504
  s_lshl_b32 s76, s71, 13
  s_add_u32 s76, s76, s25
  s_lshr_b32 s77, s71, 1
  v_mov_b32 v24, 0
  v_mov_b32 v25, 0
  v_mov_b32 v26, 0
  v_mov_b32 v27, 0
  v_lshrrev_b32 v4, 3, v1
  v_and_b32 v5, 0x70, v2
  v_lshl_add_u32 v4, v4, 10, v5
  s_or_b32 s77, s77, s69
  s_cselect_b32 s76, 2146435072, s76
  s_lshl_b32 s26, s69, 5
  s_add_u32 s26, s26, s70
  s_lshl_b32 s26, s26, 7
  s_add_u32 s26, s26, 37748736
  s_cmp_eq_u32 s71, 3
  s_cselect_b32 s76, s26, s76
  s_cselect_b64 s[60:61], 0xff, -1
  s_waitcnt vmcnt(7)
  s_mov_b64 exec, s[60:61]
  buffer_store_dwordx4 v[24:27], v4, s[32:35], s76 offen sc1
  s_mov_b64 exec, -1
  buffer_store_dwordx4 v[16:19], v2, s[32:35], s75 offen sc1
  s_mov_b64 exec, 0xffffff
  buffer_store_dwordx4 v[20:23], v2, s[32:35], s75 offen offset:1024 sc1
  s_mov_b64 exec, -1
  s_buffer_load_dword s94, s[44:47], 0
  s_add_u32 s93, s93, 229376
  s_cmp_eq_u32 s93, 1605632
  s_cselect_b32 s93, 0, s93
  s_add_u32 m0, s83, 94208
  s_add_u32 s75, s79, s93
  buffer_load_dwordx4 v32, s[36:39], s75 offen offset:0 lds
  buffer_load_dwordx4 v33, s[36:39], s75 offen offset:1024 lds
  buffer_load_dwordx4 v34, s[36:39], s75 offen offset:2048 lds
  buffer_load_dwordx4 v35, s[36:39], s75 offen offset:3072 lds
  s_add_u32 m0, s83, 98304
  s_add_u32 s75, s75, 4096
  buffer_load_dwordx4 v36, s[36:39], s75 offen offset:0 lds
  buffer_load_dwordx4 v37, s[36:39], s75 offen offset:1024 lds
  buffer_load_dwordx4 v38, s[36:39], s75 offen offset:2048 lds
  s_waitcnt lgkmcnt(0)
  s_mov_b32 s96, 0
  s_cmp_eq_u32 s94, 0
  s_cbranch_scc1 L_na32
L_ng33:
  s_mov_b32 s95, s94
  s_add_u32 s93, s93, 229376
  s_cmp_eq_u32 s93, 1605632
  s_cselect_b32 s93, 0, s93
  s_add_u32 m0, s83, 122880
  s_add_u32 s75, s79, s93
  buffer_load_dwordx4 v32, s[36:39], s75 offen offset:0 lds
  buffer_load_dwordx4 v33, s[36:39], s75 offen offset:1024 lds
  buffer_load_dwordx4 v34, s[36:39], s75 offen offset:2048 lds
  buffer_load_dwordx4 v35, s[36:39], s75 offen offset:3072 lds
  s_add_u32 m0, s83, 126976
  s_add_u32 s75, s75, 4096
  buffer_load_dwordx4 v36, s[36:39], s75 offen offset:0 lds
  buffer_load_dwordx4 v37, s[36:39], s75 offen offset:1024 lds
  buffer_load_dwordx4 v38, s[36:39], s75 offen offset:2048 lds
L_L2:
  s_waitcnt vmcnt(17)
  s_barrier
  s_setprio 3
  s_mul_i32 s77, s82, 49
  s_mul_i32 s76, s71, 13
  v_min_u32 v5, 12, v1
  v_add_u32 v5, s76, v5
  v_min_u32 v5, 48, v5
  v_add_lshl_u32 v5, v5, s77, 7
  s_mul_i32 s76, s69, 200704
  buffer_load_dword v11, v5, s[48:51], s76 offen
  s_mul_i32 s77, s82, 13
  s_mul_i32 s76, s71, 4
  v_min_u32 v5, 3, v1
  v_add_u32 v5, s76, v5
  v_min_u32 v5, 12, v5
  v_add_u32 v5, s77, v5
  v_min_u32 v5, 391, v5
  v_lshlrev_b32 v5, 7, v5
  s_mul_i32 s76, s69, 50176
  buffer_load_dword v11, v5, s[52:55], s76 offen
  s_lshl_b32 s76, s65, 7
  s_cmp_eq_u32 s65, 7
  s_cselect_b32 s76, 2146435072, s76
  s_mov_b32 m0, 161792
  s_mov_b64 exec, 0xff
  buffer_load_dwordx4 v2, s[56:59], s76 offen lds
  s_mov_b64 exec, -1
  s_waitcnt vmcnt(17)
  s_waitcnt vmcnt(10)
  s_barrier
  s_cmp_ge_u32 s71, 1
  s_cbranch_scc1 L_o034
  s_atomic_swap s94, s[32:33], s26
L_o034:
  s_add_u32 s93, s93, 229376
  s_cmp_eq_u32 s93, 1605632
  s_cselect_b32 s93, 0, s93
  s_add_u32 m0, s83, 65536
  s_add_u32 s75, s79, s93
  buffer_load_dwordx4 v32, s[36:39], s75 offen offset:0 lds
  buffer_load_dwordx4 v33, s[36:39], s75 offen offset:1024 lds
  buffer_load_dwordx4 v34, s[36:39], s75 offen offset:2048 lds
  buffer_load_dwordx4 v35, s[36:39], s75 offen offset:3072 lds
  s_add_u32 m0, s83, 69632
  s_add_u32 s75, s75, 4096
  buffer_load_dwordx4 v36, s[36:39], s75 offen offset:0 lds
  buffer_load_dwordx4 v37, s[36:39], s75 offen offset:1024 lds
  buffer_load_dwordx4 v38, s[36:39], s75 offen offset:2048 lds
  s_waitcnt vmcnt(10)
  s_barrier
  s_add_u32 s93, s93, 229376
  s_cmp_eq_u32 s93, 1605632
  s_cselect_b32 s93, 0, s93
  s_add_u32 m0, s83, 94208
  s_add_u32 s75, s79, s93
  buffer_load_dwordx4 v32, s[36:39], s75 offen offset:0 lds
  buffer_load_dwordx4 v33, s[36:39], s75 offen offset:1024 lds
  buffer_load_dwordx4 v34, s[36:39], s75 offen offset:2048 lds
  buffer_load_dwordx4 v35, s[36:39], s75 offen offset:3072 lds
  s_add_u32 m0, s83, 98304
  s_add_u32 s75, s75, 4096
  buffer_load_dwordx4 v36, s[36:39], s75 offen offset:0 lds
  buffer_load_dwordx4 v37, s[36:39], s75 offen offset:1024 lds
  buffer_load_dwordx4 v38, s[36:39], s75 offen offset:2048 lds
  s_waitcnt vmcnt(7)
  s_barrier
  s_add_u32 s93, s93, 229376
  s_cmp_eq_u32 s93, 1605632
  s_cselect_b32 s93, 0, s93
  s_add_u32 m0, s83, 122880
  s_add_u32 s75, s79, s93
  buffer_load_dwordx4 v32, s[36:39], s75 offen offset:0 lds
  buffer_load_dwordx4 v33, s[36:39], s75 offen offset:1024 lds
  buffer_load_dwordx4 v34, s[36:39], s75 offen offset:2048 lds
  buffer_load_dwordx4 v35, s[36:39], s75 offen offset:3072 lds
  s_add_u32 m0, s83, 126976
  s_add_u32 s75, s75, 4096
  buffer_load_dwordx4 v36, s[36:39], s75 offen offset:0 lds
  buffer_load_dwordx4 v37, s[36:39], s75 offen offset:1024 lds
  buffer_load_dwordx4 v38, s[36:39], s75 offen offset:2048 lds
  s_waitcnt vmcnt(7)
  s_barrier
  s_add_u32 s93, s93, 229376
  s_cmp_eq_u32 s93, 1605632
  s_cselect_b32 s93, 0, s93
  s_add_u32 m0, s83, 65536
  s_add_u32 s75, s79, s93
  buffer_load_dwordx4 v32, s[36:39], s75 offen offset:0 lds
  buffer_load_dwordx4 v33, s[36:39], s75 offen offset:1024 lds
  buffer_load_dwordx4 v34, s[36:39], s75 offen offset:2048 lds
  buffer_load_dwordx4 v35, s[36:39], s75 offen offset:3072 lds
  s_add_u32 m0, s83, 69632
  s_add_u32 s75, s75, 4096
  buffer_load_dwordx4 v36, s[36:39], s75 offen offset:0 lds
  buffer_load_dwordx4 v37, s[36:39], s75 offen offset:1024 lds
  buffer_load_dwordx4 v38, s[36:39], s75 offen offset:2048 lds
  s_waitcnt lgkmcnt(0)
  s_waitcnt vmcnt(7)
  s_barrier
  s_mul_i32 s93, s64, 22528
  s_add_u32 m0, s97, 94208
  s_add_u32 s75, s80, s93
  buffer_load_dwordx4 v2, s[32:35], s75 offen offset:0 lds
  buffer_load_dwordx4 v2, s[32:35], s75 offen offset:1024 lds
  buffer_load_dwordx4 v2, s[32:35], s75 offen offset:2048 lds
  buffer_load_dwordx4 v2, s[32:35], s75 offen offset:3072 lds
  s_add_u32 m0, s97, 98304
  s_add_u32 s75, s75, 4096
  buffer_load_dwordx4 v2, s[32:35], s75 offen offset:0 lds
  s_mov_b32 exec_hi, 0
  buffer_load_dwordx4 v2, s[32:35], s75 offen offset:1024 lds
  s_mov_b32 exec_hi, -1
  s_waitcnt vmcnt(6)
  s_barrier
  s_add_u32 s93, s93, 22528
  s_cmp_eq_u32 s93, 157696
  s_cselect_b32 s93, 0, s93
  s_add_u32 m0, s97, 122880
  s_add_u32 s75, s80, s93
  buffer_load_dwordx4 v2, s[32:35], s75 offen offset:0 lds
  buffer_load_dwordx4 v2, s[32:35], s75 offen offset:1024 lds
  buffer_load_dwordx4 v2, s[32:35], s75 offen offset:2048 lds
  buffer_load_dwordx4 v2, s[32:35], s75 offen offset:3072 lds
  s_add_u32 m0, s97, 126976
  s_add_u32 s75, s75, 4096
  buffer_load_dwordx4 v2, s[32:35], s75 offen offset:0 lds
  s_mov_b32 exec_hi, 0
  buffer_load_dwordx4 v2, s[32:35], s75 offen offset:1024 lds
  s_mov_b32 exec_hi, -1
  s_waitcnt vmcnt(6)
  s_barrier
  s_add_u32 s93, s93, 22528
  s_cmp_eq_u32 s93, 157696
  s_cselect_b32 s93, 0, s93
  s_add_u32 m0, s97, 65536
  s_add_u32 s75, s80, s93
  buffer_load_dwordx4 v2, s[32:35], s75 offen offset:0 lds
  buffer_load_dwordx4 v2, s[32:35], s75 offen offset:1024 lds
  buffer_load_dwordx4 v2, s[32:35], s75 offen offset:2048 lds
  buffer_load_dwordx4 v2, s[32:35], s75 offen offset:3072 lds
  s_add_u32 m0, s97, 69632
  s_add_u32 s75, s75, 4096
  buffer_load_dwordx4 v2, s[32:35], s75 offen offset:0 lds
  s_mov_b32 exec_hi, 0
  buffer_load_dwordx4 v2, s[32:35], s75 offen offset:1024 lds
  s_mov_b32 exec_hi, -1
  s_lshl_b32 s76, s65, 7
  s_lshl_b32 s75, s71, 5
  s_add_u32 s75, s75, s74
  s_mul_i32 s75, s75, 896
  s_cmp_eq_u32 s65, 7
  s_cselect_b32 s76, 2146435072, s76
  s_add_u32 s75, s75, s76
  s_lshl_b32 s77, s71, 11
  s_add_u32 m0, s77, 153600
  s_add_u32 s75, s75, 0
  buffer_load_dwordx4 v29, s[28:31], s75 offen lds
  s_add_u32 m0, s77, 154624
  s_add_u32 s75, s75, 14336
  buffer_load_dwordx4 v29, s[28:31], s75 offen lds
  s_waitcnt vmcnt(8)
  s_barrier
  s_add_u32 s93, s93, 22528
  s_cmp_eq_u32 s93, 157696
  s_cselect_b32 s93, 0, s93
  s_add_u32 m0, s97, 94208
  s_add_u32 s75, s80, s93
  buffer_load_dwordx4 v2, s[32:35], s75 offen offset:0 lds
  buffer_load_dwordx4 v2, s[32:35], s75 offen offset:1024 lds
  buffer_load_dwordx4 v2, s[32:35], s75 offen offset:2048 lds
  buffer_load_dwordx4 v2, s[32:35], s75 offen offset:3072 lds
  s_add_u32 m0, s97, 98304
  s_add_u32 s75, s75, 4096
  buffer_load_dwordx4 v2, s[32:35], s75 offen offset:0 lds
  s_mov_b32 exec_hi, 0
  buffer_load_dwordx4 v2, s[32:35], s75 offen offset:1024 lds
  s_mov_b32 exec_hi, -1
  s_lshl_b32 s77, s86, 7
  s_add_u32 s77, s77, s81
  s_add_u32 m0, s27, 0
  s_add_u32 s75, s77, 0
  buffer_load_dwordx4 v10, s[48:51], s75 offen lds
  s_add_u32 m0, s27, 4096
  s_add_u32 s75, s77, 28672
  buffer_load_dwordx4 v10, s[48:51], s75 offen lds
  s_waitcnt vmcnt(10)
  s_barrier
  s_add_u32 s93, s93, 22528
  s_cmp_eq_u32 s93, 157696
  s_cselect_b32 s93, 0, s93
  s_add_u32 m0, s97, 122880
  s_add_u32 s75, s80, s93
  buffer_load_dwordx4 v2, s[32:35], s75 offen offset:0 lds
  buffer_load_dwordx4 v2, s[32:35], s75 offen offset:1024 lds
  buffer_load_dwordx4 v2, s[32:35], s75 offen offset:2048 lds
  buffer_load_dwordx4 v2, s[32:35], s75 offen offset:3072 lds
  s_add_u32 m0, s97, 126976
  s_add_u32 s75, s75, 4096
  buffer_load_dwordx4 v2, s[32:35], s75 offen offset:0 lds
  s_mov_b32 exec_hi, 0
  buffer_load_dwordx4 v2, s[32:35], s75 offen offset:1024 lds
  s_mov_b32 exec_hi, -1
  s_lshl_b32 s77, s86, 7
  s_add_u32 s77, s77, s81
  s_add_u32 m0, s27, 8192
  s_add_u32 s75, s77, 57344
  buffer_load_dwordx4 v10, s[48:51], s75 offen lds
  s_add_u32 m0, s27, 12288
  s_add_u32 s75, s77, 86016
  buffer_load_dwordx4 v10, s[48:51], s75 offen lds
  s_waitcnt vmcnt(10)
  s_barrier
  s_add_u32 s93, s93, 22528
  s_cmp_eq_u32 s93, 157696
  s_cselect_b32 s93, 0, s93
  s_add_u32 m0, s97, 65536
  s_add_u32 s75, s80, s93
  buffer_load_dwordx4 v2, s[32:35], s75 offen offset:0 lds
  buffer_load_dwordx4 v2, s[32:35], s75 offen offset:1024 lds
  buffer_load_dwordx4 v2, s[32:35], s75 offen offset:2048 lds
  buffer_load_dwordx4 v2, s[32:35], s75 offen offset:3072 lds
  s_add_u32 m0, s97, 69632
  s_add_u32 s75, s75, 4096
  buffer_load_dwordx4 v2, s[32:35], s75 offen offset:0 lds
  s_mov_b32 exec_hi, 0
  buffer_load_dwordx4 v2, s[32:35], s75 offen offset:1024 lds
  s_mov_b32 exec_hi, -1
  s_lshl_b32 s77, s86, 7
  s_add_u32 s77, s77, s81
  s_add_u32 m0, s27, 16384
  s_add_u32 s75, s77, 114688
  buffer_load_dwordx4 v10, s[48:51], s75 offen lds
  s_add_u32 m0, s27, 20480
  s_add_u32 s75, s77, 143360
  buffer_load_dwordx4 v10, s[48:51], s75 offen lds
  s_waitcnt vmcnt(10)
  s_barrier
  s_add_u32 s93, s93, 22528
  s_cmp_eq_u32 s93, 157696
  s_cselect_b32 s93, 0, s93
  s_add_u32 m0, s97, 94208
  s_add_u32 s75, s80, s93
  buffer_load_dwordx4 v2, s[32:35], s75 offen offset:0 lds
  buffer_load_dwordx4 v2, s[32:35], s75 offen offset:1024 lds
  buffer_load_dwordx4 v2, s[32:35], s75 offen offset:2048 lds
  buffer_load_dwordx4 v2, s[32:35], s75 offen offset:3072 lds
  s_add_u32 m0, s97, 98304
  s_add_u32 s75, s75, 4096
  buffer_load_dwordx4 v2, s[32:35], s75 offen offset:0 lds
  s_mov_b32 exec_hi, 0
  buffer_load_dwordx4 v2, s[32:35], s75 offen offset:1024 lds
  s_mov_b32 exec_hi, -1
  s_lshl_b32 s77, s86, 7
  s_add_u32 s77, s77, s81
  s_add_u32 m0, s27, 24576
  s_add_u32 s75, s77, 172032
  buffer_load_dwordx4 v10, s[48:51], s75 offen lds
  s_lshl_b32 s77, s86, 7
  s_add_u32 m0, s20, 28672
  s_add_u32 s75, s22, s77
  buffer_load_dwordx4 v10, s[52:55], s75 offen lds
  s_add_u32 m0, s21, 28672
  s_add_u32 s75, s23, s77
  s_mov_b64 exec, s[18:19]
  buffer_load_dwordx4 v10, s[52:55], s75 offen lds
  s_mov_b64 exec, -1
  s_waitcnt vmcnt(11)
  s_barrier
  s_lshl_b32 s77, s87, 7
  s_add_u32 s77, s77, s81
  s_add_u32 m0, s27, 122880
  s_add_u32 s75, s77, 0
  buffer_load_dwordx4 v10, s[48:51], s75 offen lds
  s_add_u32 m0, s27, 126976
  s_add_u32 s75, s77, 28672
  buffer_load_dwordx4 v10, s[48:51], s75 offen lds
  s_add_u32 m0, s27, 131072
  s_add_u32 s75, s77, 57344
  buffer_load_dwordx4 v10, s[48:51], s75 offen lds
  s_add_u32 m0, s27, 135168
  s_add_u32 s75, s77, 86016
  buffer_load_dwordx4 v10, s[48:51], s75 offen lds
  s_add_u32 m0, s27, 139264
  s_add_u32 s75, s77, 114688
  buffer_load_dwordx4 v10, s[48:51], s75 offen lds
  s_add_u32 m0, s27, 143360
  s_add_u32 s75, s77, 143360
  buffer_load_dwordx4 v10, s[48:51], s75 offen lds
  s_add_u32 m0, s27, 147456
  s_add_u32 s75, s77, 172032
  buffer_load_dwordx4 v10, s[48:51], s75 offen lds
  s_lshl_b32 s77, s87, 7
  s_add_u32 m0, s20, 35840
  s_add_u32 s75, s22, s77
  buffer_load_dwordx4 v10, s[52:55], s75 offen lds
  s_add_u32 m0, s21, 35840
  s_add_u32 s75, s23, s77
  s_mov_b64 exec, s[18:19]
  buffer_load_dwordx4 v10, s[52:55], s75 offen lds
  s_mov_b64 exec, -1
  s_waitcnt vmcnt(12)
  s_barrier
  s_lshl_b32 s77, s88, 7
  s_add_u32 s77, s77, s81
  s_add_u32 m0, s27, 65536
  s_add_u32 s75, s77, 0
  buffer_load_dwordx4 v10, s[48:51], s75 offen lds
  s_add_u32 m0, s27, 69632
  s_add_u32 s75, s77, 28672
  buffer_load_dwordx4 v10, s[48:51], s75 offen lds
  s_add_u32 m0, s27, 73728
  s_add_u32 s75, s77, 57344
  buffer_load_dwordx4 v10, s[48:51], s75 offen lds
  s_add_u32 m0, s27, 77824
  s_add_u32 s75, s77, 86016
  buffer_load_dwordx4 v10, s[48:51], s75 offen lds
  s_add_u32 m0, s27, 81920
  s_add_u32 s75, s77, 114688
  buffer_load_dwordx4 v10, s[48:51], s75 offen lds
  s_add_u32 m0, s27, 86016
  s_add_u32 s75, s77, 143360
  buffer_load_dwordx4 v10, s[48:51], s75 offen lds
  s_add_u32 m0, s27, 90112
  s_add_u32 s75, s77, 172032
  buffer_load_dwordx4 v10, s[48:51], s75 offen lds
  s_cmp_ge_u32 s71, 2
  s_cbranch_scc1 L_o035
  s_buffer_load_dword s61, s[44:47], 128
L_o035:
  s_barrier
  s_waitcnt vmcnt(0)
  s_cmp_lt_u32 s71, 2
  s_cbranch_scc1 L_g636
  s_cmp_eq_u32 s65, 7
  s_cbranch_scc1 L_g636
  s_lshl_b32 s77, s92, 7
  s_sub_u32 s13, s71, 2
  s_mul_i32 s14, s69, 200704
  s_add_u32 s14, s14, s77
  s_mul_i32 s15, s69, 50176
  s_add_u32 s15, s15, s77
  s_add_u32 s75, s13, 0
  s_mul_i32 s75, s75, 7168
  s_add_u32 s75, s75, s14
  buffer_load_dwordx4 v[40:43], v10, s[48:51], s75 offen
  s_add_u32 s75, s13, 2
  s_mul_i32 s75, s75, 7168
  s_add_u32 s75, s75, s14
  buffer_load_dwordx4 v[44:47], v10, s[48:51], s75 offen
  s_add_u32 s75, s13, 4
  s_mul_i32 s75, s75, 7168
  s_add_u32 s75, s75, s14
  buffer_load_dwordx4 v[48:51], v10, s[48:51], s75 offen
  s_add_u32 s75, s13, 6
  s_mul_i32 s75, s75, 7168
  s_add_u32 s75, s75, s14
  buffer_load_dwordx4 v[52:55], v10, s[48:51], s75 offen
  s_add_u32 s75, s13, 8
  s_mul_i32 s75, s75, 7168
  s_add_u32 s75, s75, s14
  buffer_load_dwordx4 v[56:59], v10, s[48:51], s75 offen
  s_add_u32 s75, s13, 10
  s_mul_i32 s75, s75, 7168
  s_add_u32 s75, s75, s14
  buffer_load_dwordx4 v[60:63], v10, s[48:51], s75 offen
  s_add_u32 s75, s13, 12
  s_mul_i32 s75, s75, 7168
  s_add_u32 s75, s75, s14
  buffer_load_dwordx4 v[64:67], v10, s[48:51], s75 offen
  s_add_u32 s75, s13, 14
  s_mul_i32 s75, s75, 7168
  s_add_u32 s75, s75, s14
  buffer_load_dwordx4 v[68:71], v10, s[48:51], s75 offen
  s_add_u32 s75, s13, 16
  s_mul_i32 s75, s75, 7168
  s_add_u32 s75, s75, s14
  buffer_load_dwordx4 v[72:75], v10, s[48:51], s75 offen
  s_add_u32 s75, s13, 18
  s_mul_i32 s75, s75, 7168
  s_add_u32 s75, s75, s14
  buffer_load_dwordx4 v[76:79], v10, s[48:51], s75 offen
L_g636:
  s_cmp_ge_u32 s71, 2
  s_cbranch_scc1 L_o039
  s_waitcnt lgkmcnt(0)
  s_mov_b32 s96, 0
  s_cmp_ge_u32 s61, 4194304
  s_cbranch_scc0 L_ca37
L_cg38:
  s_and_b32 s61, s61, 0xffff
  s_sub_u32 s60, s61, 2036
  s_cmp_gt_u32 s61, 2048
  s_cselect_b32 s61, 1, 0
  s_cmp_lt_u32 s60, 25
  s_cselect_b32 s61, s70, s61
  s_add_u32 s60, s25, s32
  s_lshr_b32 s60, s60, 21
  s_xor_b32 s61, s61, s60
  s_lshr_b32 s60, s70, 4
  s_xor_b32 s61, s61, s60
  s_and_b32 s61, s61, 1
  s_lshl_b32 s61, s61, 13
  v_mov_b32 v4, 161924
  v_mov_b32 v5, s61
  s_mov_b64 exec, 1
  ds_write_b32 v4, v5
  s_mov_b64 exec, -1
  s_add_u32 s25, s25, s61
  s_lshl_b32 s75, s65, 17
  s_add_u32 s84, s25, s75
  s_sub_u32 s84, s84, 917504
  s_lshl_b32 s75, s65, 10
  s_add_u32 s24, s25, s75
L_o039:
  s_lshl_b32 s77, s88, 7
  s_add_u32 m0, s20, 43008
  s_add_u32 s75, s22, s77
  buffer_load_dwordx4 v10, s[52:55], s75 offen lds
  s_add_u32 m0, s21, 43008
  s_add_u32 s75, s23, s77
  s_mov_b64 exec, s[18:19]
  buffer_load_dwordx4 v10, s[52:55], s75 offen lds
  s_mov_b64 exec, -1
  s_waitcnt lgkmcnt(0)
  s_barrier
  s_cmp_lt_u32 s71, 2
  s_cbranch_scc1 L_g640
  s_cmp_eq_u32 s65, 7
  s_cbranch_scc1 L_g640
  s_add_u32 s75, s13, 20
  s_mul_i32 s75, s75, 7168
  s_add_u32 s75, s75, s14
  buffer_load_dwordx4 v[80:83], v10, s[48:51], s75 offen
  s_add_u32 s75, s13, 22
  s_mul_i32 s75, s75, 7168
  s_add_u32 s75, s75, s14
  buffer_load_dwordx4 v[84:87], v10, s[48:51], s75 offen
  s_add_u32 s75, s13, 24
  s_mul_i32 s75, s75, 7168
  s_add_u32 s75, s75, s14
  buffer_load_dwordx4 v[88:91], v10, s[48:51], s75 offen
  s_add_u32 s75, s13, 26
  s_mul_i32 s75, s75, 7168
  s_add_u32 s75, s75, s14
  buffer_load_dwordx4 v[92:95], v10, s[48:51], s75 offen
  s_add_u32 s75, s13, 0
  s_mul_i32 s75, s75, 7168
  s_add_u32 s75, s75, s15
  buffer_load_dwordx4 v[96:99], v10, s[52:55], s75 offen
  s_add_u32 s75, s13, 2
  s_mul_i32 s75, s75, 7168
  s_add_u32 s75, s75, s15
  buffer_load_dwordx4 v[100:103], v10, s[52:55], s75 offen
  s_add_u32 s75, s13, 4
  s_mul_i32 s75, s75, 7168
  s_add_u32 s75, s75, s15
  buffer_load_dwordx4 v[104:107], v10, s[52:55], s75 offen
  s_add_u32 s75, s13, 6
  s_min_u32 s75, s75, 6
  s_mul_i32 s75, s75, 7168
  s_add_u32 s75, s75, s15
  buffer_load_dwordx4 v[108:111], v10, s[52:55], s75 offen
L_g640:
  s_lshl_b32 s77, s89, 7
  s_add_u32 m0, s20, 50176
  s_add_u32 s75, s22, s77
  buffer_load_dwordx4 v10, s[52:55], s75 offen lds
  s_add_u32 m0, s21, 50176
  s_add_u32 s75, s23, s77
  s_mov_b64 exec, s[18:19]
  buffer_load_dwordx4 v10, s[52:55], s75 offen lds
  s_mov_b64 exec, -1
  s_barrier
  s_setprio 0
  s_lshl_b32 s77, s89, 7
  s_add_u32 s77, s77, s81
  s_add_u32 m0, s27, 94208
  s_add_u32 s75, s77, 0
  buffer_load_dwordx4 v10, s[48:51], s75 offen lds
  s_add_u32 m0, s27, 98304
  s_add_u32 s75, s77, 28672
  buffer_load_dwordx4 v10, s[48:51], s75 offen lds
  s_add_u32 m0, s27, 102400
  s_add_u32 s75, s77, 57344
  buffer_load_dwordx4 v10, s[48:51], s75 offen lds
  s_add_u32 m0, s27, 106496
  s_add_u32 s75, s77, 86016
  buffer_load_dwordx4 v10, s[48:51], s75 offen lds
  s_add_u32 m0, s27, 110592
  s_add_u32 s75, s77, 114688
  buffer_load_dwordx4 v10, s[48:51], s75 offen lds
  s_add_u32 m0, s27, 114688
  s_add_u32 s75, s77, 143360
  buffer_load_dwordx4 v10, s[48:51], s75 offen lds
  s_add_u32 m0, s27, 118784
  s_add_u32 s75, s77, 172032
  buffer_load_dwordx4 v10, s[48:51], s75 offen lds
  s_barrier
  s_lshl_b32 s77, s90, 7
  s_add_u32 s77, s77, s81
  s_add_u32 m0, s27, 0
  s_add_u32 s75, s77, 0
  buffer_load_dwordx4 v10, s[48:51], s75 offen lds
  s_add_u32 m0, s27, 4096
  s_add_u32 s75, s77, 28672
  buffer_load_dwordx4 v10, s[48:51], s75 offen lds
  s_add_u32 m0, s27, 8192
  s_add_u32 s75, s77, 57344
  buffer_load_dwordx4 v10, s[48:51], s75 offen lds
  s_add_u32 m0, s27, 12288
  s_add_u32 s75, s77, 86016
  buffer_load_dwordx4 v10, s[48:51], s75 offen lds
  s_add_u32 m0, s27, 16384
  s_add_u32 s75, s77, 114688
  buffer_load_dwordx4 v10, s[48:51], s75 offen lds
  s_add_u32 m0, s27, 20480
  s_add_u32 s75, s77, 143360
  buffer_load_dwordx4 v10, s[48:51], s75 offen lds
  s_add_u32 m0, s27, 24576
  s_add_u32 s75, s77, 172032
  buffer_load_dwordx4 v10, s[48:51], s75 offen lds
  s_lshl_b32 s77, s90, 7
  s_add_u32 m0, s20, 28672
  s_add_u32 s75, s22, s77
  buffer_load_dwordx4 v10, s[52:55], s75 offen lds
  s_add_u32 m0, s21, 28672
  s_add_u32 s75, s23, s77
  s_mov_b64 exec, s[18:19]
  buffer_load_dwordx4 v10, s[52:55], s75 offen lds
  s_mov_b64 exec, -1
  s_waitcnt vmcnt(18)
  s_barrier
  s_lshl_b32 s77, s91, 7
  s_add_u32 s77, s77, s81
  s_add_u32 m0, s27, 122880
  s_add_u32 s75, s77, 0
  buffer_load_dwordx4 v10, s[48:51], s75 offen lds
  s_add_u32 m0, s27, 126976
  s_add_u32 s75, s77, 28672
  buffer_load_dwordx4 v10, s[48:51], s75 offen lds
  s_add_u32 m0, s27, 131072
  s_add_u32 s75, s77, 57344
  buffer_load_dwordx4 v10, s[48:51], s75 offen lds
  s_add_u32 m0, s27, 135168
  s_add_u32 s75, s77, 86016
  buffer_load_dwordx4 v10, s[48:51], s75 offen lds
  s_add_u32 m0, s27, 139264
  s_add_u32 s75, s77, 114688
  buffer_load_dwordx4 v10, s[48:51], s75 offen lds
  s_add_u32 m0, s27, 143360
  s_add_u32 s75, s77, 143360
  buffer_load_dwordx4 v10, s[48:51], s75 offen lds
  s_add_u32 m0, s27, 147456
  s_add_u32 s75, s77, 172032
  buffer_load_dwordx4 v10, s[48:51], s75 offen lds
  s_lshl_b32 s77, s91, 7
  s_add_u32 m0, s20, 57344
  s_add_u32 s75, s22, s77
  buffer_load_dwordx4 v10, s[52:55], s75 offen lds
  s_add_u32 m0, s21, 57344
  s_add_u32 s75, s23, s77
  s_mov_b64 exec, s[18:19]
  buffer_load_dwordx4 v10, s[52:55], s75 offen lds
  s_mov_b64 exec, -1
  s_waitcnt vmcnt(18)
  s_barrier
  s_waitcnt vmcnt(9)
  s_barrier
  s_cmp_ge_u32 s71, 1
  s_cbranch_scc1 L_o041
  s_add_u32 s5, s65, 1
  s_sub_u32 s4, s5, 7
  s_min_u32 s5, s5, s4
  s_lshl_b32 s5, s5, 10
  s_add_u32 s5, s5, s25
  s_cmp_eq_u32 s65, 7
  s_cselect_b32 s4, 64, 1
  s_atomic_add s4, s[32:33], s5
L_o041:
  s_cmp_lt_u32 s71, 2
  s_cbranch_scc1 L_z42
  s_cmp_eq_u32 s65, 7
  s_cbranch_scc1 L_n746
  s_waitcnt vmcnt(0)
  s_barrier
  s_setprio 0
  s_add_u32 s75, s13, 0
  s_min_u32 s75, s75, 27
  s_lshl_b32 s75, s75, 10
  s_add_u32 s75, s75, 65536
  v_add_u32 v6, s75, v2
  ds_write_b128 v6, v[40:43] offset:0
  ds_write_b128 v6, v[44:47] offset:2048
  ds_write_b128 v6, v[48:51] offset:4096
  ds_write_b128 v6, v[52:55] offset:6144
  ds_write_b128 v6, v[56:59] offset:8192
  ds_write_b128 v6, v[60:63] offset:10240
  ds_write_b128 v6, v[64:67] offset:12288
  ds_write_b128 v6, v[68:71] offset:14336
  ds_write_b128 v6, v[72:75] offset:16384
  ds_write_b128 v6, v[76:79] offset:18432
  ds_write_b128 v6, v[80:83] offset:20480
  ds_write_b128 v6, v[84:87] offset:22528
  ds_write_b128 v6, v[88:91] offset:24576
  ds_write_b128 v6, v[92:95] offset:26624
  s_add_u32 s75, s13, 0
  s_min_u32 s75, s75, 6
  s_lshl_b32 s75, s75, 10
  s_add_u32 s75, s75, 35840
  v_add_u32 v6, s75, v2
  ds_write_b128 v6, v[96:99] offset:0
  ds_write_b128 v6, v[100:103] offset:2048
  ds_write_b128 v6, v[104:107] offset:4096
  s_add_u32 s75, s13, 6
  s_min_u32 s75, s75, 6
  s_lshl_b32 s75, s75, 10
  s_add_u32 s75, s75, 35840
  v_add_u32 v6, s75, v2
  ds_write_b128 v6, v[108:111] offset:0
  s_waitcnt lgkmcnt(0)
  v_mov_b32 v4, 161932
  v_mov_b32 v5, 1
  s_mov_b64 exec, 1
  s_waitcnt vmcnt(0)
  ds_add_u32 v4, v5
  s_mov_b64 exec, -1
  s_branch L_tf45
L_n746:
  s_lshl_b32 s77, s92, 7
  s_sub_u32 s16, s71, 2
  s_mul_i32 s17, s69, 200704
  s_add_u32 s17, s17, s77
  s_mul_i32 s18, s69, 50176
  s_add_u32 s18, s18, s77
  s_add_u32 s75, s16, 0
  s_lshl_b32 s76, s75, 10
  s_add_u32 m0, s76, 65536
  s_mul_i32 s75, s75, 7168
  s_add_u32 s75, s75, s17
  buffer_load_dwordx4 v10, s[48:51], s75 offen lds
  s_add_u32 s75, s16, 2
  s_lshl_b32 s76, s75, 10
  s_add_u32 m0, s76, 65536
  s_mul_i32 s75, s75, 7168
  s_add_u32 s75, s75, s17
  buffer_load_dwordx4 v10, s[48:51], s75 offen lds
  s_add_u32 s75, s16, 4
  s_lshl_b32 s76, s75, 10
  s_add_u32 m0, s76, 65536
  s_mul_i32 s75, s75, 7168
  s_add_u32 s75, s75, s17
  buffer_load_dwordx4 v10, s[48:51], s75 offen lds
  s_add_u32 s75, s16, 6
  s_lshl_b32 s76, s75, 10
  s_add_u32 m0, s76, 65536
  s_mul_i32 s75, s75, 7168
  s_add_u32 s75, s75, s17
  buffer_load_dwordx4 v10, s[48:51], s75 offen lds
  s_add_u32 s75, s16, 8
  s_lshl_b32 s76, s75, 10
  s_add_u32 m0, s76, 65536
  s_mul_i32 s75, s75, 7168
  s_add_u32 s75, s75, s17
  buffer_load_dwordx4 v10, s[48:51], s75 offen lds
  s_add_u32 s75, s16, 10
  s_lshl_b32 s76, s75, 10
  s_add_u32 m0, s76, 65536
  s_mul_i32 s75, s75, 7168
  s_add_u32 s75, s75, s17
  buffer_load_dwordx4 v10, s[48:51], s75 offen lds
  s_add_u32 s75, s16, 12
  s_lshl_b32 s76, s75, 10
  s_add_u32 m0, s76, 65536
  s_mul_i32 s75, s75, 7168
  s_add_u32 s75, s75, s17
  buffer_load_dwordx4 v10, s[48:51], s75 offen lds
  s_add_u32 s75, s16, 14
  s_lshl_b32 s76, s75, 10
  s_add_u32 m0, s76, 65536
  s_mul_i32 s75, s75, 7168
  s_add_u32 s75, s75, s17
  buffer_load_dwordx4 v10, s[48:51], s75 offen lds
  s_add_u32 s75, s16, 16
  s_lshl_b32 s76, s75, 10
  s_add_u32 m0, s76, 65536
  s_mul_i32 s75, s75, 7168
  s_add_u32 s75, s75, s17
  buffer_load_dwordx4 v10, s[48:51], s75 offen lds
  s_add_u32 s75, s16, 18
  s_lshl_b32 s76, s75, 10
  s_add_u32 m0, s76, 65536
  s_mul_i32 s75, s75, 7168
  s_add_u32 s75, s75, s17
  buffer_load_dwordx4 v10, s[48:51], s75 offen lds
  s_add_u32 s75, s16, 20
  s_lshl_b32 s76, s75, 10
  s_add_u32 m0, s76, 65536
  s_mul_i32 s75, s75, 7168
  s_add_u32 s75, s75, s17
  buffer_load_dwordx4 v10, s[48:51], s75 offen lds
  s_add_u32 s75, s16, 22
  s_lshl_b32 s76, s75, 10
  s_add_u32 m0, s76, 65536
  s_mul_i32 s75, s75, 7168
  s_add_u32 s75, s75, s17
  buffer_load_dwordx4 v10, s[48:51], s75 offen lds
  s_add_u32 s75, s16, 24
  s_lshl_b32 s76, s75, 10
  s_add_u32 m0, s76, 65536
  s_mul_i32 s75, s75, 7168
  s_add_u32 s75, s75, s17
  buffer_load_dwordx4 v10, s[48:51], s75 offen lds
  s_add_u32 s75, s16, 26
  s_lshl_b32 s76, s75, 10
  s_add_u32 m0, s76, 65536
  s_mul_i32 s75, s75, 7168
  s_add_u32 s75, s75, s17
  buffer_load_dwordx4 v10, s[48:51], s75 offen lds
  s_add_u32 s75, s16, 0
  s_lshl_b32 s76, s75, 10
  s_add_u32 m0, s76, 35840
  s_mul_i32 s75, s75, 7168
  s_add_u32 s75, s75, s18
  buffer_load_dwordx4 v10, s[52:55], s75 offen lds
  s_add_u32 s75, s16, 2
  s_lshl_b32 s76, s75, 10
  s_add_u32 m0, s76, 35840
  s_mul_i32 s75, s75, 7168
  s_add_u32 s75, s75, s18
  buffer_load_dwordx4 v10, s[52:55], s75 offen lds
  s_add_u32 s75, s16, 4
  s_lshl_b32 s76, s75, 10
  s_add_u32 m0, s76, 35840
  s_mul_i32 s75, s75, 7168
  s_add_u32 s75, s75, s18
  buffer_load_dwordx4 v10, s[52:55], s75 offen lds
  s_add_u32 s75, s16, 6
  s_min_u32 s75, s75, 6
  s_lshl_b32 s76, s75, 10
  s_add_u32 m0, s76, 35840
  s_mul_i32 s75, s75, 7168
  s_add_u32 s75, s75, s18
  buffer_load_dwordx4 v10, s[52:55], s75 offen lds
  s_waitcnt vmcnt(18)
  s_barrier
  v_mov_b32 v4, 161932
  v_mov_b32 v5, 1
  s_mov_b64 exec, 1
  s_waitcnt vmcnt(0)
  ds_add_u32 v4, v5
  s_mov_b64 exec, -1
  s_branch L_tf45
L_z42:
  s_cmp_eq_u32 s71, 0
  s_cselect_b32 s12, 7, 120
  s_cmp_eq_u32 s65, 7
  s_cselect_b32 s12, 0x7f, s12
  s_mov_b32 s13, 0
  s_cmp_eq_u32 s71, 1
  s_cbranch_scc0 L_np47
  s_load_dword s13, s[32:33], s24 glc
L_np47:
  s_waitcnt vmcnt(0)
  s_barrier
  s_cmp_ge_u32 s71, 1
  s_cbranch_scc1 L_o050
  s_add_u32 s7, s65, 2
  s_sub_u32 s6, s7, 7
  s_min_u32 s7, s7, s6
  s_lshl_b32 s7, s7, 10
  s_add_u32 s7, s7, s25
  s_cmp_eq_u32 s65, 7
  s_cselect_b32 s6, 64, 2
  s_atomic_add s6, s[32:33], s7
  s_add_u32 s9, s65, 3
  s_sub_u32 s8, s9, 7
  s_min_u32 s9, s9, s8
  s_lshl_b32 s9, s9, 10
  s_add_u32 s9, s9, s25
  s_cmp_eq_u32 s65, 7
  s_cselect_b32 s8, 64, 4
  s_atomic_add s8, s[32:33], s9
L_o050:
  s_cmp_lg_u32 s71, 1
  s_cbranch_scc1 L_nw51
  s_waitcnt lgkmcnt(0)
  s_and_b32 s13, s13, 0x7f
L_nw51:
  s_mov_b32 s96, 0
  s_add_u32 s17, s65, 6
  .p2align 6
L_tl43:
  s_andn2_b32 s14, s13, s12
  s_cbranch_scc0 L_ta52
  s_ff1_i32_b32 s14, s14
  s_bitset1_b32 s12, s14
  s_sub_u32 s15, s17, s14
  s_sub_u32 s16, s15, 7
  s_min_u32 s15, s15, s16
  s_cmp_eq_u32 s14, 6
  s_cselect_b32 s15, 7, s15
  s_lshl_b32 s15, s15, 14
  s_add_u32 s15, s15, s84
  s_cmp_lt_u32 s14, 3
  s_cselect_b32 s16, 29, 0
  s_lshl_b32 s14, s14, 1
  s_add_u32 s14, s14, s16
  s_sub_u32 s14, s14, 6
  s_lshl_b32 m0, s14, 12
  s_add_u32 s16, s15, 4096
  buffer_load_dwordx4 v2, s[32:35], s15 offen offset:0 sc1 lds
  buffer_load_dwordx4 v2, s[32:35], s15 offen offset:1024 sc1 lds
  buffer_load_dwordx4 v2, s[32:35], s15 offen offset:2048 sc1 lds
  buffer_load_dwordx4 v2, s[32:35], s15 offen offset:3072 sc1 lds
  s_add_u32 m0, m0, 4096
  s_cmp_eq_u32 s12, 0x7f
  buffer_load_dwordx4 v2, s[32:35], s16 offen offset:0 sc1 lds
  buffer_load_dwordx4 v2, s[32:35], s16 offen offset:1024 sc1 lds
  buffer_load_dwordx4 v2, s[32:35], s16 offen offset:2048 sc1 lds
  buffer_load_dwordx4 v2, s[32:35], s16 offen offset:3072 sc1 lds
  s_cbranch_scc0 L_tl43
L_ta52:
  s_add_u32 s96, s96, 1
  s_cmp_gt_u32 s96, 200000
  s_cselect_b32 s12, 0x7f, s12
  s_cmp_eq_u32 s12, 0x7f
  s_cbranch_scc1 L_to44
  s_load_dword s13, s[32:33], s24 glc
  s_waitcnt lgkmcnt(0)
  s_and_b32 s13, s13, 0x7f
  s_branch L_tl43
L_to44:
  s_waitcnt vmcnt(0)
  s_cmp_eq_u32 s71, 0
  s_cbranch_scc1 L_tf45
  v_mov_b32 v4, 161936
  v_mov_b32 v5, 1
  s_mov_b64 exec, 1
  s_waitcnt vmcnt(0)
  ds_add_u32 v4, v5
  s_mov_b64 exec, -1
L_tf45:
  s_cmp_eq_u32 s65, 7
  s_cbranch_scc1 L_Lend
  s_barrier
L_Lend:
L_fin:
L_end:
  s_endpgm
L_s72:
  v_mov_b32 v28, 0
  v_mov_b32 v29, 0
  v_mov_b32 v30, 0
  v_mov_b32 v31, 0
  v_mov_b32 v32, 0
  v_mov_b32 v33, 0
  v_mov_b32 v34, 0
  v_mov_b32 v35, 0
  s_branch L_ns1
L_na12:
  v_mov_b32 v4, 0
  s_add_u32 s96, s96, 1
  buffer_load_dword v4, v4, s[44:47], 0 offen sc1
  s_cmp_gt_u32 s96, 200000
  s_waitcnt vmcnt(0)
  v_readfirstlane_b32 s94, v4
  s_cbranch_scc1 L_ng13
  s_cmp_eq_u32 s94, 0
  s_cbranch_scc1 L_na12
  s_branch L_ng13
L_pr15:
  v_min_u32 v5, 6, v1
  v_lshlrev_b32 v5, 7, v5
  s_add_u32 s96, s96, 1
  buffer_load_dword v5, v5, s[32:35], s78 offen sc1
  s_cmp_gt_u32 s96, 200000
  s_waitcnt vmcnt(0)
  v_cmp_ne_u32 vcc, s94, v5
  s_cbranch_scc1 L_pg16
  s_nop 1
  s_cbranch_vccnz L_pr15
  s_branch L_pg16
L_s721:
  v_mov_b32 v28, 0
  v_mov_b32 v29, 0
  v_mov_b32 v30, 0
  v_mov_b32 v31, 0
  v_mov_b32 v32, 0
  v_mov_b32 v33, 0
  v_mov_b32 v34, 0
  v_mov_b32 v35, 0
  s_branch L_ns20
L_na32:
  v_mov_b32 v4, 0
  s_add_u32 s96, s96, 1
  buffer_load_dword v4, v4, s[44:47], 0 offen sc1
  s_cmp_gt_u32 s96, 200000
  s_waitcnt vmcnt(0)
  v_readfirstlane_b32 s94, v4
  s_cbranch_scc1 L_ng33
  s_cmp_eq_u32 s94, 0
  s_cbranch_scc1 L_na32
  s_branch L_ng33
L_ca37:
  buffer_load_dword v4, v15, s[44:47], 0 offen offset:128 sc1
  s_add_u32 s96, s96, 1
  s_cmp_gt_u32 s96, 200000
  s_waitcnt vmcnt(0)
  v_readfirstlane_b32 s61, v4
  s_cbranch_scc1 L_cg38
  s_cmp_ge_u32 s61, 4194304
  s_cbranch_scc0 L_ca37
  s_branch L_cg38
L_codeend:
.section .rodata,"a"
.p2align 6
.amdhsa_kernel parallel_sum__sliding_local_dilated__dense_activation_gelu__prompt_kernel
  .amdhsa_next_free_vgpr 168
  .amdhsa_next_free_sgpr 102
  .amdhsa_accum_offset 168
  .amdhsa_group_segment_fixed_size 0
  .amdhsa_kernarg_size 88
  .amdhsa_user_sgpr_count 2
  .amdhsa_user_sgpr_kernarg_segment_ptr 1
  .amdhsa_system_sgpr_workgroup_id_x 1
.end_amdhsa_kernel
```
